```python
import torch

def _softmax(x, axis=-1):
    return torch.softmax(x, dim=axis)
def _gelu(x):
    return torch.nn.functional.gelu(x, approximate="tanh")
def _silu(x):
    return torch.nn.functional.silu(x)
def _sigmoid(x):
    return torch.sigmoid(x)
def _layernorm(x, axis=-1, eps=1e-5):
    m = x.mean(dim=axis, keepdim=True)
    v = x.var(dim=axis, keepdim=True, unbiased=False)
    return (x - m) / torch.sqrt(v + eps)
def _scatter_add(tgt, idx, src, axis=0):
    return tgt.clone().index_add_(axis, idx, src)
def _segment_sum(src, seg, n):
    out = torch.zeros((n,) + src.shape[1:], dtype=src.dtype)
    return out.index_add_(0, seg, src)
def _pad(x, pw):
    flat = tuple(v for pair in reversed(pw) for v in pair)
    return torch.nn.functional.pad(x, flat)

kernel_name = 'recurrent_scan__spectral_gfnet__dense_activation_silu__prompt'

def setup_inputs():

    _w = (lambda a: (lambda t: t.to(torch.bfloat16) if t.is_floating_point() else t)(torch.as_tensor(a)))
    def _A_setup():
        B, S, D = 1, 2048, 512
        Df = D // 2 + 1
        return {
            "x": _w((lambda *s: torch.randn(*s, dtype=torch.bfloat16) * 0.05)(B, S, D)),
            "w_r": _w((lambda *s: torch.randn(*s, dtype=torch.bfloat16) * 3.2)(S, Df) * 0.02),
            "w_i": _w((lambda *s: torch.randn(*s, dtype=torch.bfloat16) * 3.2)(S, Df) * 0.02),
        }
    _A_in = _A_setup()

    def _B_setup():
        B, S, D, F = 1, 2048, 512, 1376
        return {
            "x": _w((lambda *s: torch.randn(*s, dtype=torch.bfloat16) * 0.05)(B, S, D)),
            "w1": _w((lambda *s: torch.randn(*s, dtype=torch.bfloat16) * 3.2)(D, F) * (D ** -0.5)),
            "w2": _w((lambda *s: torch.randn(*s, dtype=torch.bfloat16) * 0.4)(F, D) * (F ** -0.5)),
        }
    _B_in = _B_setup()

    return {
        "A_x": _A_in["x"],
        "A_w_r": _A_in["w_r"],
        "A_w_i": _A_in["w_i"],
        "B_x": _B_in["x"],
        "B_w1": _B_in["w1"],
        "B_w2": _B_in["w2"],
    }

def reference(A_x, A_w_r, A_w_i, B_x, B_w1, B_w2):
    def _A_ref(x, w_r, w_i):
        B, S, D = x.shape
        X = (lambda x, axes=(-2,-1): torch.fft.rfft2(x.float(), dim=axes))(x, axes=(-2, -1))
        W = w_r + 1j * w_i
        X = X * W
        y = (lambda x, s, axes=(-2,-1): torch.fft.irfft2(x, s=s, dim=axes).to(torch.bfloat16))(X, (S, D), axes=(-2, -1))
        return y

    def _B_ref(x, w1, w2):
        h = torch.einsum("bsd,df->bsf", x, w1)
        h = _silu(h)
        out = torch.einsum("bsf,fd->bsd", h, w2)
        return out

    x = A_x
    xn = _layernorm(x, axis=-1)
    s = _A_ref(xn, A_w_r, A_w_i)
    g = _silu(_B_ref(xn, B_w1, B_w2))
    return x + s * g
```

```asm
; @launch kernel=k1_kernel grid=(432,1,1) block=(512,1,1) lds=77824
; @launch kernel=k2_kernel grid=(513,1,1) block=(256,1,1) lds=43008
; @launch kernel=k3_kernel grid=(256,1,1) block=(512,1,1) lds=32896
.amdgcn_target "amdgcn-amd-amdhsa--gfx950"
.text
.globl k1_kernel
.p2align 8
.type k1_kernel,@function
k1_kernel:
    s_cmp_ge_u32 s2, 432
    s_cbranch_scc1 L_k1_kernel_end
    s_cmp_lt_u32 s2, 176
    s_cbranch_scc1 L_k1_gemm
    s_sub_u32 s2, s2, 176
    s_load_dwordx2 s[4:5], s[0:1], 0
    s_load_dwordx2 s[6:7], s[0:1], 8
    s_load_dwordx2 s[8:9], s[0:1], 16
    s_load_dwordx2 s[10:11], s[0:1], 64
    v_and_b32 v1, 63, v0
    v_lshrrev_b32 v2, 6, v0
    s_nop 0
    v_readfirstlane_b32 s28, v2
    s_lshl_b32 s29, s2, 3
    s_add_u32 s29, s29, s28
    s_waitcnt lgkmcnt(0)
    s_mov_b32 s12, s4
    s_and_b32 s13, s5, 0xffff
    s_mov_b32 s14, 2097152
    s_mov_b32 s15, 0x00020000
    s_mov_b32 s16, s6
    s_and_b32 s17, s7, 0xffff
    s_mov_b32 s18, 1052672
    s_mov_b32 s19, 0x00020000
    s_mov_b32 s20, s8
    s_and_b32 s21, s9, 0xffff
    s_mov_b32 s22, 1052672
    s_mov_b32 s23, 0x00020000
    s_mov_b32 s24, s10
    s_and_b32 s25, s11, 0xffff
    s_mov_b32 s26, 268435456
    s_mov_b32 s27, 0x00020000
    s_lshl_b32 s30, s29, 10
    v_lshlrev_b32 v2, 2, v1
    v_add_u32 v2, s30, v2
    buffer_load_dword v8, v2, s[12:15], 0 offen offset:0
    buffer_load_dword v9, v2, s[12:15], 0 offen offset:256
    buffer_load_dword v10, v2, s[12:15], 0 offen offset:512
    buffer_load_dword v11, v2, s[12:15], 0 offen offset:768
    s_mul_i32 s30, s29, 514
    v_lshlrev_b32 v3, 1, v1
    v_add_u32 v3, s30, v3
    v_mov_b32 v4, s30
    buffer_load_ushort v12, v3, s[16:19], 0 offen offset:0
    buffer_load_ushort v13, v3, s[16:19], 0 offen offset:128
    buffer_load_ushort v14, v3, s[16:19], 0 offen offset:256
    buffer_load_ushort v15, v3, s[16:19], 0 offen offset:384
    buffer_load_ushort v16, v4, s[16:19], 0 offen offset:512
    buffer_load_ushort v17, v3, s[20:23], 0 offen offset:0
    buffer_load_ushort v18, v3, s[20:23], 0 offen offset:128
    buffer_load_ushort v19, v3, s[20:23], 0 offen offset:256
    buffer_load_ushort v20, v3, s[20:23], 0 offen offset:384
    buffer_load_ushort v21, v4, s[20:23], 0 offen offset:512
    s_lshl_b32 s31, s28, 11
    s_waitcnt vmcnt(10)
    v_lshlrev_b32 v22, 16, v8
    v_and_b32 v23, 0xffff0000, v8
    v_lshlrev_b32 v24, 16, v9
    v_and_b32 v25, 0xffff0000, v9
    v_lshlrev_b32 v26, 16, v10
    v_and_b32 v27, 0xffff0000, v10
    v_lshlrev_b32 v28, 16, v11
    v_and_b32 v29, 0xffff0000, v11
    v_add_f32 v8, v22, v23
    v_add_f32 v8, v8, v24
    v_add_f32 v8, v8, v25
    v_add_f32 v8, v8, v26
    v_add_f32 v8, v8, v27
    v_add_f32 v8, v8, v28
    v_add_f32 v8, v8, v29
    s_nop 1
    v_add_f32_dpp v8, v8, v8 row_shr:1 row_mask:0xf bank_mask:0xf bound_ctrl:0
    s_nop 1
    v_add_f32_dpp v8, v8, v8 row_shr:2 row_mask:0xf bank_mask:0xf bound_ctrl:0
    s_nop 1
    v_add_f32_dpp v8, v8, v8 row_shr:4 row_mask:0xf bank_mask:0xf bound_ctrl:0
    s_nop 1
    v_add_f32_dpp v8, v8, v8 row_shr:8 row_mask:0xf bank_mask:0xf bound_ctrl:0
    s_nop 1
    v_add_f32_dpp v8, v8, v8 row_bcast:15 row_mask:0xa bank_mask:0xf
    s_nop 1
    v_add_f32_dpp v8, v8, v8 row_bcast:31 row_mask:0xc bank_mask:0xf
    s_nop 0
    v_readlane_b32 s32, v8, 63
    s_nop 1
    v_mov_b32 v5, s32
    v_mul_f32 v5, 0x3b000000, v5
    v_mov_b32 v9, 0
    v_sub_f32 v8, v22, v5
    v_fma_f32 v9, v8, v8, v9
    v_sub_f32 v8, v23, v5
    v_fma_f32 v9, v8, v8, v9
    v_sub_f32 v8, v24, v5
    v_fma_f32 v9, v8, v8, v9
    v_sub_f32 v8, v25, v5
    v_fma_f32 v9, v8, v8, v9
    v_sub_f32 v8, v26, v5
    v_fma_f32 v9, v8, v8, v9
    v_sub_f32 v8, v27, v5
    v_fma_f32 v9, v8, v8, v9
    v_sub_f32 v8, v28, v5
    v_fma_f32 v9, v8, v8, v9
    v_sub_f32 v8, v29, v5
    v_fma_f32 v9, v8, v8, v9
    s_nop 1
    v_add_f32_dpp v9, v9, v9 row_shr:1 row_mask:0xf bank_mask:0xf bound_ctrl:0
    s_nop 1
    v_add_f32_dpp v9, v9, v9 row_shr:2 row_mask:0xf bank_mask:0xf bound_ctrl:0
    s_nop 1
    v_add_f32_dpp v9, v9, v9 row_shr:4 row_mask:0xf bank_mask:0xf bound_ctrl:0
    s_nop 1
    v_add_f32_dpp v9, v9, v9 row_shr:8 row_mask:0xf bank_mask:0xf bound_ctrl:0
    s_nop 1
    v_add_f32_dpp v9, v9, v9 row_bcast:15 row_mask:0xa bank_mask:0xf
    s_nop 1
    v_add_f32_dpp v9, v9, v9 row_bcast:31 row_mask:0xc bank_mask:0xf
    s_nop 0
    v_readlane_b32 s33, v9, 63
    s_nop 1
    v_mov_b32 v6, s33
    v_mul_f32 v6, 0x3b000000, v6
    v_cvt_pk_bf16_f32 v5, v5, v5
    v_lshlrev_b32 v5, 16, v5
    v_cvt_pk_bf16_f32 v6, v6, v6
    v_lshlrev_b32 v6, 16, v6
    v_add_f32 v6, 0x3727c5ac, v6
    v_cvt_pk_bf16_f32 v6, v6, v6
    v_lshlrev_b32 v6, 16, v6
    v_sqrt_f32 v6, v6
    s_nop 0
    v_cvt_pk_bf16_f32 v6, v6, v6
    v_lshlrev_b32 v6, 16, v6
    v_rcp_f32 v6, v6
    v_sub_f32 v22, v22, v5
    v_cvt_pk_bf16_f32 v22, v22, v22
    v_lshlrev_b32 v22, 16, v22
    v_mul_f32 v22, v22, v6
    v_cvt_pk_bf16_f32 v22, v22, v22
    v_lshlrev_b32 v22, 16, v22
    v_sub_f32 v23, v23, v5
    v_cvt_pk_bf16_f32 v23, v23, v23
    v_lshlrev_b32 v23, 16, v23
    v_mul_f32 v23, v23, v6
    v_cvt_pk_bf16_f32 v23, v23, v23
    v_lshlrev_b32 v23, 16, v23
    v_sub_f32 v24, v24, v5
    v_cvt_pk_bf16_f32 v24, v24, v24
    v_lshlrev_b32 v24, 16, v24
    v_mul_f32 v24, v24, v6
    v_cvt_pk_bf16_f32 v24, v24, v24
    v_lshlrev_b32 v24, 16, v24
    v_sub_f32 v25, v25, v5
    v_cvt_pk_bf16_f32 v25, v25, v25
    v_lshlrev_b32 v25, 16, v25
    v_mul_f32 v25, v25, v6
    v_cvt_pk_bf16_f32 v25, v25, v25
    v_lshlrev_b32 v25, 16, v25
    v_sub_f32 v26, v26, v5
    v_cvt_pk_bf16_f32 v26, v26, v26
    v_lshlrev_b32 v26, 16, v26
    v_mul_f32 v26, v26, v6
    v_cvt_pk_bf16_f32 v26, v26, v26
    v_lshlrev_b32 v26, 16, v26
    v_sub_f32 v27, v27, v5
    v_cvt_pk_bf16_f32 v27, v27, v27
    v_lshlrev_b32 v27, 16, v27
    v_mul_f32 v27, v27, v6
    v_cvt_pk_bf16_f32 v27, v27, v27
    v_lshlrev_b32 v27, 16, v27
    v_sub_f32 v28, v28, v5
    v_cvt_pk_bf16_f32 v28, v28, v28
    v_lshlrev_b32 v28, 16, v28
    v_mul_f32 v28, v28, v6
    v_cvt_pk_bf16_f32 v28, v28, v28
    v_lshlrev_b32 v28, 16, v28
    v_sub_f32 v29, v29, v5
    v_cvt_pk_bf16_f32 v29, v29, v29
    v_lshlrev_b32 v29, 16, v29
    v_mul_f32 v29, v29, v6
    v_cvt_pk_bf16_f32 v29, v29, v29
    v_lshlrev_b32 v29, 16, v29
    s_waitcnt vmcnt(0)
    v_lshl_or_b32 v12, v17, 16, v12
    v_lshl_or_b32 v13, v18, 16, v13
    v_lshl_or_b32 v14, v19, 16, v14
    v_lshl_or_b32 v15, v20, 16, v15
    v_lshl_or_b32 v16, v21, 16, v16
    v_lshlrev_b32 v2, 5, v1
    s_lshl_b32 s34, s28, 2
    s_add_u32 s34, s34, 34896
    v_add_u32 v2, s34, v2
    ds_write_b32 v2, v12 offset:0
    ds_write_b32 v2, v13 offset:2048
    ds_write_b32 v2, v14 offset:4096
    ds_write_b32 v2, v15 offset:6144
    v_mov_b32 v3, s34
    ds_write_b32 v3, v16 offset:8192
    v_lshlrev_b32 v8, 3, v1
    v_add_u32 v8, s31, v8
    v_add_f32 v10, v22, v26
    v_add_f32 v11, v23, v27
    v_sub_f32 v12, v22, v26
    v_sub_f32 v13, v23, v27
    v_add_f32 v14, v24, v28
    v_add_f32 v15, v25, v29
    v_sub_f32 v16, v24, v28
    v_sub_f32 v17, v25, v29
    v_add_f32 v18, v10, v14
    v_add_f32 v19, v11, v15
    v_sub_f32 v20, v10, v14
    v_sub_f32 v21, v11, v15
    v_add_f32 v22, v12, v17
    v_sub_f32 v23, v13, v16
    v_sub_f32 v24, v12, v17
    v_add_f32 v25, v13, v16
    v_and_b32 v9, 0, v1
    v_lshrrev_b32 v2, 0, v1
    v_lshl_add_u32 v9, v2, 2, v9
    v_lshlrev_b32 v9, 3, v9
    v_add_u32 v9, s31, v9
    ds_write_b64 v9, v[18:19] offset:0
    ds_write_b64 v9, v[22:23] offset:8
    ds_write_b64 v9, v[20:21] offset:16
    ds_write_b64 v9, v[24:25] offset:24
    s_waitcnt lgkmcnt(0)
    ds_read_b64 v[18:19], v8 offset:0
    ds_read_b64 v[22:23], v8 offset:512
    ds_read_b64 v[20:21], v8 offset:1024
    ds_read_b64 v[24:25], v8 offset:1536
    s_waitcnt lgkmcnt(0)
    v_and_b32 v9, 3, v1
    v_cvt_f32_u32 v9, v9
    v_mul_f32 v10, 0.0625, v9
    v_cos_f32 v11, v10
    v_sin_f32 v12, v10
    s_nop 0
    v_sub_f32 v12, 0, v12
    v_mul_f32 v14, v22, v11
    v_mul_f32 v15, v23, v11
    v_fma_f32 v14, -v23, v12, v14
    v_fma_f32 v15, v22, v12, v15
    v_mul_f32 v10, 0.125, v9
    v_cos_f32 v11, v10
    v_sin_f32 v12, v10
    s_nop 0
    v_sub_f32 v12, 0, v12
    v_mul_f32 v16, v20, v11
    v_mul_f32 v17, v21, v11
    v_fma_f32 v16, -v21, v12, v16
    v_fma_f32 v17, v20, v12, v17
    v_mul_f32 v10, 0.1875, v9
    v_cos_f32 v11, v10
    v_sin_f32 v12, v10
    s_nop 0
    v_sub_f32 v12, 0, v12
    v_mul_f32 v20, v24, v11
    v_mul_f32 v21, v25, v11
    v_fma_f32 v20, -v25, v12, v20
    v_fma_f32 v21, v24, v12, v21
    v_add_f32 v10, v18, v16
    v_add_f32 v11, v19, v17
    v_sub_f32 v12, v18, v16
    v_sub_f32 v13, v19, v17
    v_add_f32 v22, v14, v20
    v_add_f32 v23, v15, v21
    v_sub_f32 v24, v14, v20
    v_sub_f32 v25, v15, v21
    v_add_f32 v14, v10, v22
    v_add_f32 v15, v11, v23
    v_sub_f32 v16, v10, v22
    v_sub_f32 v17, v11, v23
    v_add_f32 v18, v12, v25
    v_sub_f32 v19, v13, v24
    v_sub_f32 v20, v12, v25
    v_add_f32 v21, v13, v24
    v_and_b32 v9, 3, v1
    v_lshrrev_b32 v2, 2, v1
    v_lshl_add_u32 v9, v2, 4, v9
    v_lshlrev_b32 v9, 3, v9
    v_add_u32 v9, s31, v9
    ds_write_b64 v9, v[14:15] offset:0
    ds_write_b64 v9, v[18:19] offset:32
    ds_write_b64 v9, v[16:17] offset:64
    ds_write_b64 v9, v[20:21] offset:96
    s_waitcnt lgkmcnt(0)
    ds_read_b64 v[14:15], v8 offset:0
    ds_read_b64 v[18:19], v8 offset:512
    ds_read_b64 v[16:17], v8 offset:1024
    ds_read_b64 v[20:21], v8 offset:1536
    s_waitcnt lgkmcnt(0)
    v_and_b32 v9, 15, v1
    v_cvt_f32_u32 v9, v9
    v_mul_f32 v10, 0.015625, v9
    v_cos_f32 v11, v10
    v_sin_f32 v12, v10
    s_nop 0
    v_sub_f32 v12, 0, v12
    v_mul_f32 v22, v18, v11
    v_mul_f32 v23, v19, v11
    v_fma_f32 v22, -v19, v12, v22
    v_fma_f32 v23, v18, v12, v23
    v_mul_f32 v10, 0.03125, v9
    v_cos_f32 v11, v10
    v_sin_f32 v12, v10
    s_nop 0
    v_sub_f32 v12, 0, v12
    v_mul_f32 v18, v16, v11
    v_mul_f32 v19, v17, v11
    v_fma_f32 v18, -v17, v12, v18
    v_fma_f32 v19, v16, v12, v19
    v_mul_f32 v10, 0.046875, v9
    v_cos_f32 v11, v10
    v_sin_f32 v12, v10
    s_nop 0
    v_sub_f32 v12, 0, v12
    v_mul_f32 v16, v20, v11
    v_mul_f32 v17, v21, v11
    v_fma_f32 v16, -v21, v12, v16
    v_fma_f32 v17, v20, v12, v17
    v_add_f32 v10, v14, v18
    v_add_f32 v11, v15, v19
    v_sub_f32 v12, v14, v18
    v_sub_f32 v13, v15, v19
    v_add_f32 v20, v22, v16
    v_add_f32 v21, v23, v17
    v_sub_f32 v24, v22, v16
    v_sub_f32 v25, v23, v17
    v_add_f32 v14, v10, v20
    v_add_f32 v15, v11, v21
    v_sub_f32 v16, v10, v20
    v_sub_f32 v17, v11, v21
    v_add_f32 v18, v12, v25
    v_sub_f32 v19, v13, v24
    v_sub_f32 v22, v12, v25
    v_add_f32 v23, v13, v24
    v_and_b32 v9, 15, v1
    v_lshrrev_b32 v2, 4, v1
    v_lshl_add_u32 v9, v2, 6, v9
    v_lshlrev_b32 v9, 3, v9
    v_add_u32 v9, s31, v9
    ds_write_b64 v9, v[14:15] offset:0
    ds_write_b64 v9, v[18:19] offset:128
    ds_write_b64 v9, v[16:17] offset:256
    ds_write_b64 v9, v[22:23] offset:384
    s_waitcnt lgkmcnt(0)
    ds_read_b64 v[14:15], v8 offset:0
    ds_read_b64 v[18:19], v8 offset:512
    ds_read_b64 v[16:17], v8 offset:1024
    ds_read_b64 v[22:23], v8 offset:1536
    s_waitcnt lgkmcnt(0)
    v_and_b32 v9, 63, v1
    v_cvt_f32_u32 v9, v9
    v_mul_f32 v10, 0.00390625, v9
    v_cos_f32 v11, v10
    v_sin_f32 v12, v10
    s_nop 0
    v_sub_f32 v12, 0, v12
    v_mul_f32 v20, v18, v11
    v_mul_f32 v21, v19, v11
    v_fma_f32 v20, -v19, v12, v20
    v_fma_f32 v21, v18, v12, v21
    v_mul_f32 v10, 0.0078125, v9
    v_cos_f32 v11, v10
    v_sin_f32 v12, v10
    s_nop 0
    v_sub_f32 v12, 0, v12
    v_mul_f32 v18, v16, v11
    v_mul_f32 v19, v17, v11
    v_fma_f32 v18, -v17, v12, v18
    v_fma_f32 v19, v16, v12, v19
    v_mul_f32 v10, 0.01171875, v9
    v_cos_f32 v11, v10
    v_sin_f32 v12, v10
    s_nop 0
    v_sub_f32 v12, 0, v12
    v_mul_f32 v16, v22, v11
    v_mul_f32 v17, v23, v11
    v_fma_f32 v16, -v23, v12, v16
    v_fma_f32 v17, v22, v12, v17
    v_add_f32 v10, v14, v18
    v_add_f32 v11, v15, v19
    v_sub_f32 v12, v14, v18
    v_sub_f32 v13, v15, v19
    v_add_f32 v22, v20, v16
    v_add_f32 v23, v21, v17
    v_sub_f32 v24, v20, v16
    v_sub_f32 v25, v21, v17
    v_add_f32 v14, v10, v22
    v_add_f32 v15, v11, v23
    v_sub_f32 v16, v10, v22
    v_sub_f32 v17, v11, v23
    v_add_f32 v18, v12, v25
    v_sub_f32 v19, v13, v24
    v_sub_f32 v20, v12, v25
    v_add_f32 v21, v13, v24
    ds_write_b64 v8, v[14:15] offset:0
    ds_write_b64 v8, v[18:19] offset:512
    ds_write_b64 v8, v[16:17] offset:1024
    ds_write_b64 v8, v[20:21] offset:1536
    s_waitcnt lgkmcnt(0)
    v_sub_u32 v2, 256, v1
    v_and_b32 v2, 255, v2
    v_lshlrev_b32 v2, 3, v2
    v_add_u32 v2, s31, v2
    ds_read_b64 v[10:11], v2
    v_sub_u32 v2, 192, v1
    v_and_b32 v2, 255, v2
    v_lshlrev_b32 v2, 3, v2
    v_add_u32 v2, s31, v2
    ds_read_b64 v[12:13], v2
    v_sub_u32 v2, 128, v1
    v_and_b32 v2, 255, v2
    v_lshlrev_b32 v2, 3, v2
    v_add_u32 v2, s31, v2
    ds_read_b64 v[22:23], v2
    v_sub_u32 v2, 64, v1
    v_and_b32 v2, 255, v2
    v_lshlrev_b32 v2, 3, v2
    v_add_u32 v2, s31, v2
    ds_read_b64 v[24:25], v2
    s_lshl_b32 s34, s28, 3
    s_add_u32 s34, s34, 16384
    v_mul_u32_u24 v9, 72, v1
    v_add_u32 v9, s34, v9
    v_cvt_f32_u32 v26, v1
    s_waitcnt lgkmcnt(0)
    v_add_f32 v27, 0.0, v26
    v_mul_f32 v27, 0x3b000000, v27
    v_cos_f32 v28, v27
    v_sin_f32 v29, v27
    v_add_f32 v32, v14, v10
    v_sub_f32 v33, v15, v11
    v_sub_f32 v34, v14, v10
    v_add_f32 v35, v15, v11
    v_fma_f32 v30, v28, v35, v32
    v_fma_f32 v30, -v29, v34, v30
    v_fma_f32 v31, -v28, v34, v33
    v_fma_f32 v31, -v29, v35, v31
    ds_write_b64 v9, v[30:31] offset:0
    v_sub_f32 v6, v14, v15
    v_add_f32 v6, v6, v6
    v_mov_b32 v7, 0
    v_mov_b32 v2, s34
    s_mov_b64 s[36:37], exec
    s_mov_b64 exec, 1
    ds_write_b64 v2, v[6:7] offset:18432
    s_mov_b64 exec, s[36:37]
    v_add_f32 v27, 64.0, v26
    v_mul_f32 v27, 0x3b000000, v27
    v_cos_f32 v28, v27
    v_sin_f32 v29, v27
    v_add_f32 v32, v18, v12
    v_sub_f32 v33, v19, v13
    v_sub_f32 v34, v18, v12
    v_add_f32 v35, v19, v13
    v_fma_f32 v30, v28, v35, v32
    v_fma_f32 v30, -v29, v34, v30
    v_fma_f32 v31, -v28, v34, v33
    v_fma_f32 v31, -v29, v35, v31
    ds_write_b64 v9, v[30:31] offset:4608
    v_add_f32 v27, 128.0, v26
    v_mul_f32 v27, 0x3b000000, v27
    v_cos_f32 v28, v27
    v_sin_f32 v29, v27
    v_add_f32 v32, v16, v22
    v_sub_f32 v33, v17, v23
    v_sub_f32 v34, v16, v22
    v_add_f32 v35, v17, v23
    v_fma_f32 v30, v28, v35, v32
    v_fma_f32 v30, -v29, v34, v30
    v_fma_f32 v31, -v28, v34, v33
    v_fma_f32 v31, -v29, v35, v31
    ds_write_b64 v9, v[30:31] offset:9216
    v_add_f32 v27, 192.0, v26
    v_mul_f32 v27, 0x3b000000, v27
    v_cos_f32 v28, v27
    v_sin_f32 v29, v27
    v_add_f32 v32, v20, v24
    v_sub_f32 v33, v21, v25
    v_sub_f32 v34, v20, v24
    v_add_f32 v35, v21, v25
    v_fma_f32 v30, v28, v35, v32
    v_fma_f32 v30, -v29, v34, v30
    v_fma_f32 v31, -v28, v34, v33
    v_fma_f32 v31, -v29, v35, v31
    ds_write_b64 v9, v[30:31] offset:13824
    s_waitcnt lgkmcnt(0)
    s_barrier
    v_lshrrev_b32 v2, 2, v0
    v_and_b32 v3, 3, v0
    v_mul_u32_u24 v4, 72, v2
    v_lshlrev_b32 v5, 4, v3
    v_add_u32 v4, v4, v5
    v_add_u32 v4, 16384, v4
    v_lshlrev_b32 v6, 14, v2
    s_lshl_b32 s35, s2, 6
    v_add3_u32 v6, v6, v5, s35
    ds_read2_b64 v[8:11], v4 offset0:0 offset1:1
    s_waitcnt lgkmcnt(0)
    buffer_store_dwordx4 v[8:11], v6, s[24:27], 0 offen
    v_add_u32 v6, 0x200000, v6
    v_add_u32 v7, 9216, v4
    ds_read2_b64 v[8:11], v7 offset0:0 offset1:1
    s_waitcnt lgkmcnt(0)
    buffer_store_dwordx4 v[8:11], v6, s[24:27], 0 offen
    v_add_u32 v6, 0x200000, v6
    v_cmp_gt_u32 vcc, 4, v0
    s_and_saveexec_b64 s[36:37], vcc
    v_add_u32 v7, 18432, v4
    ds_read2_b64 v[8:11], v7 offset0:0 offset1:1
    s_waitcnt lgkmcnt(0)
    buffer_store_dwordx4 v[8:11], v6, s[24:27], 0 offen
    s_mov_b64 exec, s[36:37]
    v_lshrrev_b32 v2, 1, v0
    v_and_b32 v3, 1, v0
    v_lshlrev_b32 v4, 5, v2
    v_lshlrev_b32 v5, 4, v3
    v_add_u32 v4, v4, v5
    v_add_u32 v4, 34896, v4
    v_lshlrev_b32 v6, 13, v2
    s_lshl_b32 s35, s2, 5
    s_add_u32 s35, s35, 8388608
    v_add3_u32 v6, v6, v5, s35
    ds_read_b128 v[12:15], v4 offset:0
    s_waitcnt lgkmcnt(0)
    buffer_store_dwordx4 v[12:15], v6, s[24:27], 0 offen
    v_add_u32 v6, 0x200000, v6
    v_cmp_gt_u32 vcc, 2, v0
    s_and_saveexec_b64 s[36:37], vcc
    ds_read_b128 v[12:15], v4 offset:8192
    s_waitcnt lgkmcnt(0)
    buffer_store_dwordx4 v[12:15], v6, s[24:27], 0 offen
    s_mov_b64 exec, s[36:37]
    s_endpgm
L_k1_gemm:
    s_load_dwordx2 s[4:5], s[0:1], 0
    s_load_dwordx2 s[6:7], s[0:1], 32
    s_load_dwordx2 s[10:11], s[0:1], 64
    s_sub_u32 s28, s2, 0
    s_mul_hi_u32 s29, s28, 0x1745d175
    s_mul_i32 s30, s29, 11
    s_sub_u32 s30, s28, s30
    s_waitcnt lgkmcnt(0)
    s_mov_b32 s12, s4
    s_and_b32 s13, s5, 0xffff
    s_mov_b32 s14, 2097152
    s_mov_b32 s15, 0x00020000
    s_mov_b32 s16, s6
    s_and_b32 s17, s7, 0xffff
    s_mov_b32 s18, 1409024
    s_mov_b32 s19, 0x00020000
    s_mov_b32 s24, s10
    s_and_b32 s25, s11, 0xffff
    s_mov_b32 s26, 268435456
    s_mov_b32 s27, 0x00020000
    v_lshrrev_b32 v2, 2, v0
    v_and_b32 v3, 3, v0
    s_lshl_b32 s31, s29, 17
    v_lshlrev_b32 v4, 10, v2
    v_lshl_add_u32 v4, v3, 5, v4
    v_add_u32 v4, s31, v4
    buffer_load_dwordx4 v[48:51], v4, s[12:15], 0 offen offset:0
    buffer_load_dwordx4 v[52:55], v4, s[12:15], 0 offen offset:16
    buffer_load_dwordx4 v[56:59], v4, s[12:15], 0 offen offset:128
    buffer_load_dwordx4 v[60:63], v4, s[12:15], 0 offen offset:144
    buffer_load_dwordx4 v[64:67], v4, s[12:15], 0 offen offset:256
    buffer_load_dwordx4 v[68:71], v4, s[12:15], 0 offen offset:272
    buffer_load_dwordx4 v[72:75], v4, s[12:15], 0 offen offset:384
    buffer_load_dwordx4 v[76:79], v4, s[12:15], 0 offen offset:400
    buffer_load_dwordx4 v[80:83], v4, s[12:15], 0 offen offset:512
    buffer_load_dwordx4 v[84:87], v4, s[12:15], 0 offen offset:528
    buffer_load_dwordx4 v[88:91], v4, s[12:15], 0 offen offset:640
    buffer_load_dwordx4 v[92:95], v4, s[12:15], 0 offen offset:656
    buffer_load_dwordx4 v[96:99], v4, s[12:15], 0 offen offset:768
    buffer_load_dwordx4 v[100:103], v4, s[12:15], 0 offen offset:784
    buffer_load_dwordx4 v[104:107], v4, s[12:15], 0 offen offset:896
    buffer_load_dwordx4 v[108:111], v4, s[12:15], 0 offen offset:912
    v_lshrrev_b32 v5, 3, v0
    v_and_b32 v6, 7, v0
    s_mov_b32 s33, 2752
    v_mul_lo_u32 v7, v5, s33
    v_lshl_add_u32 v7, v6, 5, v7
    s_lshl_b32 s34, s30, 8
    v_add_u32 v7, s34, v7
    s_mov_b32 s44, 0
    v_mul_u32_u24 v8, 144, v2
    v_lshl_add_u32 v8, v3, 5, v8
    v_mul_u32_u24 v9, 320, v5
    v_lshl_add_u32 v9, v6, 5, v9
    v_add_u32 v9, 18432, v9
    v_and_b32 v10, 63, v0
    v_lshrrev_b32 v11, 6, v0
    v_and_b32 v12, 3, v11
    v_lshrrev_b32 v13, 2, v11
    v_and_b32 v14, 31, v10
    v_lshl_add_u32 v14, v12, 5, v14
    v_mul_u32_u24 v14, 144, v14
    v_lshrrev_b32 v15, 5, v10
    v_lshl_add_u32 v14, v15, 4, v14
    v_lshlrev_b32 v15, 3, v15
    v_bfe_u32 v16, v10, 2, 2
    v_add_u32 v15, v15, v16
    v_mul_u32_u24 v15, 320, v15
    v_bfe_u32 v16, v10, 4, 1
    v_lshlrev_b32 v16, 5, v16
    v_and_b32 v17, 3, v10
    v_lshl_add_u32 v16, v17, 3, v16
    v_lshl_add_u32 v16, v13, 7, v16
    v_add_u32 v15, v15, v16
    v_add_u32 v15, 18432, v15
    s_waitcnt vmcnt(0)
    v_mov_b32 v18, 0
    v_mov_b32 v19, 0
    v_lshlrev_b32 v20, 16, v48
    v_and_b32 v21, 0xffff0000, v48
    v_add_f32 v18, v18, v20
    v_add_f32 v19, v19, v21
    v_lshlrev_b32 v20, 16, v49
    v_and_b32 v21, 0xffff0000, v49
    v_add_f32 v18, v18, v20
    v_add_f32 v19, v19, v21
    v_lshlrev_b32 v20, 16, v50
    v_and_b32 v21, 0xffff0000, v50
    v_add_f32 v18, v18, v20
    v_add_f32 v19, v19, v21
    v_lshlrev_b32 v20, 16, v51
    v_and_b32 v21, 0xffff0000, v51
    v_add_f32 v18, v18, v20
    v_add_f32 v19, v19, v21
    v_lshlrev_b32 v20, 16, v52
    v_and_b32 v21, 0xffff0000, v52
    v_add_f32 v18, v18, v20
    v_add_f32 v19, v19, v21
    v_lshlrev_b32 v20, 16, v53
    v_and_b32 v21, 0xffff0000, v53
    v_add_f32 v18, v18, v20
    v_add_f32 v19, v19, v21
    v_lshlrev_b32 v20, 16, v54
    v_and_b32 v21, 0xffff0000, v54
    v_add_f32 v18, v18, v20
    v_add_f32 v19, v19, v21
    v_lshlrev_b32 v20, 16, v55
    v_and_b32 v21, 0xffff0000, v55
    v_add_f32 v18, v18, v20
    v_add_f32 v19, v19, v21
    v_lshlrev_b32 v20, 16, v56
    v_and_b32 v21, 0xffff0000, v56
    v_add_f32 v18, v18, v20
    v_add_f32 v19, v19, v21
    v_lshlrev_b32 v20, 16, v57
    v_and_b32 v21, 0xffff0000, v57
    v_add_f32 v18, v18, v20
    v_add_f32 v19, v19, v21
    v_lshlrev_b32 v20, 16, v58
    v_and_b32 v21, 0xffff0000, v58
    v_add_f32 v18, v18, v20
    v_add_f32 v19, v19, v21
    v_lshlrev_b32 v20, 16, v59
    v_and_b32 v21, 0xffff0000, v59
    v_add_f32 v18, v18, v20
    v_add_f32 v19, v19, v21
    v_lshlrev_b32 v20, 16, v60
    v_and_b32 v21, 0xffff0000, v60
    v_add_f32 v18, v18, v20
    v_add_f32 v19, v19, v21
    v_lshlrev_b32 v20, 16, v61
    v_and_b32 v21, 0xffff0000, v61
    v_add_f32 v18, v18, v20
    v_add_f32 v19, v19, v21
    v_lshlrev_b32 v20, 16, v62
    v_and_b32 v21, 0xffff0000, v62
    v_add_f32 v18, v18, v20
    v_add_f32 v19, v19, v21
    v_lshlrev_b32 v20, 16, v63
    v_and_b32 v21, 0xffff0000, v63
    v_add_f32 v18, v18, v20
    v_add_f32 v19, v19, v21
    v_lshlrev_b32 v20, 16, v64
    v_and_b32 v21, 0xffff0000, v64
    v_add_f32 v18, v18, v20
    v_add_f32 v19, v19, v21
    v_lshlrev_b32 v20, 16, v65
    v_and_b32 v21, 0xffff0000, v65
    v_add_f32 v18, v18, v20
    v_add_f32 v19, v19, v21
    v_lshlrev_b32 v20, 16, v66
    v_and_b32 v21, 0xffff0000, v66
    v_add_f32 v18, v18, v20
    v_add_f32 v19, v19, v21
    v_lshlrev_b32 v20, 16, v67
    v_and_b32 v21, 0xffff0000, v67
    v_add_f32 v18, v18, v20
    v_add_f32 v19, v19, v21
    v_lshlrev_b32 v20, 16, v68
    v_and_b32 v21, 0xffff0000, v68
    v_add_f32 v18, v18, v20
    v_add_f32 v19, v19, v21
    v_lshlrev_b32 v20, 16, v69
    v_and_b32 v21, 0xffff0000, v69
    v_add_f32 v18, v18, v20
    v_add_f32 v19, v19, v21
    v_lshlrev_b32 v20, 16, v70
    v_and_b32 v21, 0xffff0000, v70
    v_add_f32 v18, v18, v20
    v_add_f32 v19, v19, v21
    v_lshlrev_b32 v20, 16, v71
    v_and_b32 v21, 0xffff0000, v71
    v_add_f32 v18, v18, v20
    v_add_f32 v19, v19, v21
    v_lshlrev_b32 v20, 16, v72
    v_and_b32 v21, 0xffff0000, v72
    v_add_f32 v18, v18, v20
    v_add_f32 v19, v19, v21
    v_lshlrev_b32 v20, 16, v73
    v_and_b32 v21, 0xffff0000, v73
    v_add_f32 v18, v18, v20
    v_add_f32 v19, v19, v21
    v_lshlrev_b32 v20, 16, v74
    v_and_b32 v21, 0xffff0000, v74
    v_add_f32 v18, v18, v20
    v_add_f32 v19, v19, v21
    v_lshlrev_b32 v20, 16, v75
    v_and_b32 v21, 0xffff0000, v75
    v_add_f32 v18, v18, v20
    v_add_f32 v19, v19, v21
    v_lshlrev_b32 v20, 16, v76
    v_and_b32 v21, 0xffff0000, v76
    v_add_f32 v18, v18, v20
    v_add_f32 v19, v19, v21
    v_lshlrev_b32 v20, 16, v77
    v_and_b32 v21, 0xffff0000, v77
    v_add_f32 v18, v18, v20
    v_add_f32 v19, v19, v21
    v_lshlrev_b32 v20, 16, v78
    v_and_b32 v21, 0xffff0000, v78
    v_add_f32 v18, v18, v20
    v_add_f32 v19, v19, v21
    v_lshlrev_b32 v20, 16, v79
    v_and_b32 v21, 0xffff0000, v79
    v_add_f32 v18, v18, v20
    v_add_f32 v19, v19, v21
    v_lshlrev_b32 v20, 16, v80
    v_and_b32 v21, 0xffff0000, v80
    v_add_f32 v18, v18, v20
    v_add_f32 v19, v19, v21
    v_lshlrev_b32 v20, 16, v81
    v_and_b32 v21, 0xffff0000, v81
    v_add_f32 v18, v18, v20
    v_add_f32 v19, v19, v21
    v_lshlrev_b32 v20, 16, v82
    v_and_b32 v21, 0xffff0000, v82
    v_add_f32 v18, v18, v20
    v_add_f32 v19, v19, v21
    v_lshlrev_b32 v20, 16, v83
    v_and_b32 v21, 0xffff0000, v83
    v_add_f32 v18, v18, v20
    v_add_f32 v19, v19, v21
    v_lshlrev_b32 v20, 16, v84
    v_and_b32 v21, 0xffff0000, v84
    v_add_f32 v18, v18, v20
    v_add_f32 v19, v19, v21
    v_lshlrev_b32 v20, 16, v85
    v_and_b32 v21, 0xffff0000, v85
    v_add_f32 v18, v18, v20
    v_add_f32 v19, v19, v21
    v_lshlrev_b32 v20, 16, v86
    v_and_b32 v21, 0xffff0000, v86
    v_add_f32 v18, v18, v20
    v_add_f32 v19, v19, v21
    v_lshlrev_b32 v20, 16, v87
    v_and_b32 v21, 0xffff0000, v87
    v_add_f32 v18, v18, v20
    v_add_f32 v19, v19, v21
    v_lshlrev_b32 v20, 16, v88
    v_and_b32 v21, 0xffff0000, v88
    v_add_f32 v18, v18, v20
    v_add_f32 v19, v19, v21
    v_lshlrev_b32 v20, 16, v89
    v_and_b32 v21, 0xffff0000, v89
    v_add_f32 v18, v18, v20
    v_add_f32 v19, v19, v21
    v_lshlrev_b32 v20, 16, v90
    v_and_b32 v21, 0xffff0000, v90
    v_add_f32 v18, v18, v20
    v_add_f32 v19, v19, v21
    v_lshlrev_b32 v20, 16, v91
    v_and_b32 v21, 0xffff0000, v91
    v_add_f32 v18, v18, v20
    v_add_f32 v19, v19, v21
    v_lshlrev_b32 v20, 16, v92
    v_and_b32 v21, 0xffff0000, v92
    v_add_f32 v18, v18, v20
    v_add_f32 v19, v19, v21
    v_lshlrev_b32 v20, 16, v93
    v_and_b32 v21, 0xffff0000, v93
    v_add_f32 v18, v18, v20
    v_add_f32 v19, v19, v21
    v_lshlrev_b32 v20, 16, v94
    v_and_b32 v21, 0xffff0000, v94
    v_add_f32 v18, v18, v20
    v_add_f32 v19, v19, v21
    v_lshlrev_b32 v20, 16, v95
    v_and_b32 v21, 0xffff0000, v95
    v_add_f32 v18, v18, v20
    v_add_f32 v19, v19, v21
    v_lshlrev_b32 v20, 16, v96
    v_and_b32 v21, 0xffff0000, v96
    v_add_f32 v18, v18, v20
    v_add_f32 v19, v19, v21
    v_lshlrev_b32 v20, 16, v97
    v_and_b32 v21, 0xffff0000, v97
    v_add_f32 v18, v18, v20
    v_add_f32 v19, v19, v21
    v_lshlrev_b32 v20, 16, v98
    v_and_b32 v21, 0xffff0000, v98
    v_add_f32 v18, v18, v20
    v_add_f32 v19, v19, v21
    v_lshlrev_b32 v20, 16, v99
    v_and_b32 v21, 0xffff0000, v99
    v_add_f32 v18, v18, v20
    v_add_f32 v19, v19, v21
    v_lshlrev_b32 v20, 16, v100
    v_and_b32 v21, 0xffff0000, v100
    v_add_f32 v18, v18, v20
    v_add_f32 v19, v19, v21
    v_lshlrev_b32 v20, 16, v101
    v_and_b32 v21, 0xffff0000, v101
    v_add_f32 v18, v18, v20
    v_add_f32 v19, v19, v21
    v_lshlrev_b32 v20, 16, v102
    v_and_b32 v21, 0xffff0000, v102
    v_add_f32 v18, v18, v20
    v_add_f32 v19, v19, v21
    v_lshlrev_b32 v20, 16, v103
    v_and_b32 v21, 0xffff0000, v103
    v_add_f32 v18, v18, v20
    v_add_f32 v19, v19, v21
    v_lshlrev_b32 v20, 16, v104
    v_and_b32 v21, 0xffff0000, v104
    v_add_f32 v18, v18, v20
    v_add_f32 v19, v19, v21
    v_lshlrev_b32 v20, 16, v105
    v_and_b32 v21, 0xffff0000, v105
    v_add_f32 v18, v18, v20
    v_add_f32 v19, v19, v21
    v_lshlrev_b32 v20, 16, v106
    v_and_b32 v21, 0xffff0000, v106
    v_add_f32 v18, v18, v20
    v_add_f32 v19, v19, v21
    v_lshlrev_b32 v20, 16, v107
    v_and_b32 v21, 0xffff0000, v107
    v_add_f32 v18, v18, v20
    v_add_f32 v19, v19, v21
    v_lshlrev_b32 v20, 16, v108
    v_and_b32 v21, 0xffff0000, v108
    v_add_f32 v18, v18, v20
    v_add_f32 v19, v19, v21
    v_lshlrev_b32 v20, 16, v109
    v_and_b32 v21, 0xffff0000, v109
    v_add_f32 v18, v18, v20
    v_add_f32 v19, v19, v21
    v_lshlrev_b32 v20, 16, v110
    v_and_b32 v21, 0xffff0000, v110
    v_add_f32 v18, v18, v20
    v_add_f32 v19, v19, v21
    v_lshlrev_b32 v20, 16, v111
    v_and_b32 v21, 0xffff0000, v111
    v_add_f32 v18, v18, v20
    v_add_f32 v19, v19, v21
    v_add_f32 v18, v18, v19
    s_nop 1
    v_add_f32_dpp v18, v18, v18 quad_perm:[1,0,3,2] row_mask:0xf bank_mask:0xf
    s_nop 1
    v_add_f32_dpp v18, v18, v18 quad_perm:[2,3,0,1] row_mask:0xf bank_mask:0xf
    v_mul_f32 v18, 0x3b000000, v18
    v_mov_b32 v19, 0
    v_mov_b32 v22, 0
    v_lshlrev_b32 v20, 16, v48
    v_and_b32 v21, 0xffff0000, v48
    v_sub_f32 v20, v20, v18
    v_sub_f32 v21, v21, v18
    v_fma_f32 v19, v20, v20, v19
    v_fma_f32 v22, v21, v21, v22
    v_lshlrev_b32 v20, 16, v49
    v_and_b32 v21, 0xffff0000, v49
    v_sub_f32 v20, v20, v18
    v_sub_f32 v21, v21, v18
    v_fma_f32 v19, v20, v20, v19
    v_fma_f32 v22, v21, v21, v22
    v_lshlrev_b32 v20, 16, v50
    v_and_b32 v21, 0xffff0000, v50
    v_sub_f32 v20, v20, v18
    v_sub_f32 v21, v21, v18
    v_fma_f32 v19, v20, v20, v19
    v_fma_f32 v22, v21, v21, v22
    v_lshlrev_b32 v20, 16, v51
    v_and_b32 v21, 0xffff0000, v51
    v_sub_f32 v20, v20, v18
    v_sub_f32 v21, v21, v18
    v_fma_f32 v19, v20, v20, v19
    v_fma_f32 v22, v21, v21, v22
    v_lshlrev_b32 v20, 16, v52
    v_and_b32 v21, 0xffff0000, v52
    v_sub_f32 v20, v20, v18
    v_sub_f32 v21, v21, v18
    v_fma_f32 v19, v20, v20, v19
    v_fma_f32 v22, v21, v21, v22
    v_lshlrev_b32 v20, 16, v53
    v_and_b32 v21, 0xffff0000, v53
    v_sub_f32 v20, v20, v18
    v_sub_f32 v21, v21, v18
    v_fma_f32 v19, v20, v20, v19
    v_fma_f32 v22, v21, v21, v22
    v_lshlrev_b32 v20, 16, v54
    v_and_b32 v21, 0xffff0000, v54
    v_sub_f32 v20, v20, v18
    v_sub_f32 v21, v21, v18
    v_fma_f32 v19, v20, v20, v19
    v_fma_f32 v22, v21, v21, v22
    v_lshlrev_b32 v20, 16, v55
    v_and_b32 v21, 0xffff0000, v55
    v_sub_f32 v20, v20, v18
    v_sub_f32 v21, v21, v18
    v_fma_f32 v19, v20, v20, v19
    v_fma_f32 v22, v21, v21, v22
    v_lshlrev_b32 v20, 16, v56
    v_and_b32 v21, 0xffff0000, v56
    v_sub_f32 v20, v20, v18
    v_sub_f32 v21, v21, v18
    v_fma_f32 v19, v20, v20, v19
    v_fma_f32 v22, v21, v21, v22
    v_lshlrev_b32 v20, 16, v57
    v_and_b32 v21, 0xffff0000, v57
    v_sub_f32 v20, v20, v18
    v_sub_f32 v21, v21, v18
    v_fma_f32 v19, v20, v20, v19
    v_fma_f32 v22, v21, v21, v22
    v_lshlrev_b32 v20, 16, v58
    v_and_b32 v21, 0xffff0000, v58
    v_sub_f32 v20, v20, v18
    v_sub_f32 v21, v21, v18
    v_fma_f32 v19, v20, v20, v19
    v_fma_f32 v22, v21, v21, v22
    v_lshlrev_b32 v20, 16, v59
    v_and_b32 v21, 0xffff0000, v59
    v_sub_f32 v20, v20, v18
    v_sub_f32 v21, v21, v18
    v_fma_f32 v19, v20, v20, v19
    v_fma_f32 v22, v21, v21, v22
    v_lshlrev_b32 v20, 16, v60
    v_and_b32 v21, 0xffff0000, v60
    v_sub_f32 v20, v20, v18
    v_sub_f32 v21, v21, v18
    v_fma_f32 v19, v20, v20, v19
    v_fma_f32 v22, v21, v21, v22
    v_lshlrev_b32 v20, 16, v61
    v_and_b32 v21, 0xffff0000, v61
    v_sub_f32 v20, v20, v18
    v_sub_f32 v21, v21, v18
    v_fma_f32 v19, v20, v20, v19
    v_fma_f32 v22, v21, v21, v22
    v_lshlrev_b32 v20, 16, v62
    v_and_b32 v21, 0xffff0000, v62
    v_sub_f32 v20, v20, v18
    v_sub_f32 v21, v21, v18
    v_fma_f32 v19, v20, v20, v19
    v_fma_f32 v22, v21, v21, v22
    v_lshlrev_b32 v20, 16, v63
    v_and_b32 v21, 0xffff0000, v63
    v_sub_f32 v20, v20, v18
    v_sub_f32 v21, v21, v18
    v_fma_f32 v19, v20, v20, v19
    v_fma_f32 v22, v21, v21, v22
    v_lshlrev_b32 v20, 16, v64
    v_and_b32 v21, 0xffff0000, v64
    v_sub_f32 v20, v20, v18
    v_sub_f32 v21, v21, v18
    v_fma_f32 v19, v20, v20, v19
    v_fma_f32 v22, v21, v21, v22
    v_lshlrev_b32 v20, 16, v65
    v_and_b32 v21, 0xffff0000, v65
    v_sub_f32 v20, v20, v18
    v_sub_f32 v21, v21, v18
    v_fma_f32 v19, v20, v20, v19
    v_fma_f32 v22, v21, v21, v22
    v_lshlrev_b32 v20, 16, v66
    v_and_b32 v21, 0xffff0000, v66
    v_sub_f32 v20, v20, v18
    v_sub_f32 v21, v21, v18
    v_fma_f32 v19, v20, v20, v19
    v_fma_f32 v22, v21, v21, v22
    v_lshlrev_b32 v20, 16, v67
    v_and_b32 v21, 0xffff0000, v67
    v_sub_f32 v20, v20, v18
    v_sub_f32 v21, v21, v18
    v_fma_f32 v19, v20, v20, v19
    v_fma_f32 v22, v21, v21, v22
    v_lshlrev_b32 v20, 16, v68
    v_and_b32 v21, 0xffff0000, v68
    v_sub_f32 v20, v20, v18
    v_sub_f32 v21, v21, v18
    v_fma_f32 v19, v20, v20, v19
    v_fma_f32 v22, v21, v21, v22
    v_lshlrev_b32 v20, 16, v69
    v_and_b32 v21, 0xffff0000, v69
    v_sub_f32 v20, v20, v18
    v_sub_f32 v21, v21, v18
    v_fma_f32 v19, v20, v20, v19
    v_fma_f32 v22, v21, v21, v22
    v_lshlrev_b32 v20, 16, v70
    v_and_b32 v21, 0xffff0000, v70
    v_sub_f32 v20, v20, v18
    v_sub_f32 v21, v21, v18
    v_fma_f32 v19, v20, v20, v19
    v_fma_f32 v22, v21, v21, v22
    v_lshlrev_b32 v20, 16, v71
    v_and_b32 v21, 0xffff0000, v71
    v_sub_f32 v20, v20, v18
    v_sub_f32 v21, v21, v18
    v_fma_f32 v19, v20, v20, v19
    v_fma_f32 v22, v21, v21, v22
    v_lshlrev_b32 v20, 16, v72
    v_and_b32 v21, 0xffff0000, v72
    v_sub_f32 v20, v20, v18
    v_sub_f32 v21, v21, v18
    v_fma_f32 v19, v20, v20, v19
    v_fma_f32 v22, v21, v21, v22
    v_lshlrev_b32 v20, 16, v73
    v_and_b32 v21, 0xffff0000, v73
    v_sub_f32 v20, v20, v18
    v_sub_f32 v21, v21, v18
    v_fma_f32 v19, v20, v20, v19
    v_fma_f32 v22, v21, v21, v22
    v_lshlrev_b32 v20, 16, v74
    v_and_b32 v21, 0xffff0000, v74
    v_sub_f32 v20, v20, v18
    v_sub_f32 v21, v21, v18
    v_fma_f32 v19, v20, v20, v19
    v_fma_f32 v22, v21, v21, v22
    v_lshlrev_b32 v20, 16, v75
    v_and_b32 v21, 0xffff0000, v75
    v_sub_f32 v20, v20, v18
    v_sub_f32 v21, v21, v18
    v_fma_f32 v19, v20, v20, v19
    v_fma_f32 v22, v21, v21, v22
    v_lshlrev_b32 v20, 16, v76
    v_and_b32 v21, 0xffff0000, v76
    v_sub_f32 v20, v20, v18
    v_sub_f32 v21, v21, v18
    v_fma_f32 v19, v20, v20, v19
    v_fma_f32 v22, v21, v21, v22
    v_lshlrev_b32 v20, 16, v77
    v_and_b32 v21, 0xffff0000, v77
    v_sub_f32 v20, v20, v18
    v_sub_f32 v21, v21, v18
    v_fma_f32 v19, v20, v20, v19
    v_fma_f32 v22, v21, v21, v22
    v_lshlrev_b32 v20, 16, v78
    v_and_b32 v21, 0xffff0000, v78
    v_sub_f32 v20, v20, v18
    v_sub_f32 v21, v21, v18
    v_fma_f32 v19, v20, v20, v19
    v_fma_f32 v22, v21, v21, v22
    v_lshlrev_b32 v20, 16, v79
    v_and_b32 v21, 0xffff0000, v79
    v_sub_f32 v20, v20, v18
    v_sub_f32 v21, v21, v18
    v_fma_f32 v19, v20, v20, v19
    v_fma_f32 v22, v21, v21, v22
    v_lshlrev_b32 v20, 16, v80
    v_and_b32 v21, 0xffff0000, v80
    v_sub_f32 v20, v20, v18
    v_sub_f32 v21, v21, v18
    v_fma_f32 v19, v20, v20, v19
    v_fma_f32 v22, v21, v21, v22
    v_lshlrev_b32 v20, 16, v81
    v_and_b32 v21, 0xffff0000, v81
    v_sub_f32 v20, v20, v18
    v_sub_f32 v21, v21, v18
    v_fma_f32 v19, v20, v20, v19
    v_fma_f32 v22, v21, v21, v22
    v_lshlrev_b32 v20, 16, v82
    v_and_b32 v21, 0xffff0000, v82
    v_sub_f32 v20, v20, v18
    v_sub_f32 v21, v21, v18
    v_fma_f32 v19, v20, v20, v19
    v_fma_f32 v22, v21, v21, v22
    v_lshlrev_b32 v20, 16, v83
    v_and_b32 v21, 0xffff0000, v83
    v_sub_f32 v20, v20, v18
    v_sub_f32 v21, v21, v18
    v_fma_f32 v19, v20, v20, v19
    v_fma_f32 v22, v21, v21, v22
    v_lshlrev_b32 v20, 16, v84
    v_and_b32 v21, 0xffff0000, v84
    v_sub_f32 v20, v20, v18
    v_sub_f32 v21, v21, v18
    v_fma_f32 v19, v20, v20, v19
    v_fma_f32 v22, v21, v21, v22
    v_lshlrev_b32 v20, 16, v85
    v_and_b32 v21, 0xffff0000, v85
    v_sub_f32 v20, v20, v18
    v_sub_f32 v21, v21, v18
    v_fma_f32 v19, v20, v20, v19
    v_fma_f32 v22, v21, v21, v22
    v_lshlrev_b32 v20, 16, v86
    v_and_b32 v21, 0xffff0000, v86
    v_sub_f32 v20, v20, v18
    v_sub_f32 v21, v21, v18
    v_fma_f32 v19, v20, v20, v19
    v_fma_f32 v22, v21, v21, v22
    v_lshlrev_b32 v20, 16, v87
    v_and_b32 v21, 0xffff0000, v87
    v_sub_f32 v20, v20, v18
    v_sub_f32 v21, v21, v18
    v_fma_f32 v19, v20, v20, v19
    v_fma_f32 v22, v21, v21, v22
    v_lshlrev_b32 v20, 16, v88
    v_and_b32 v21, 0xffff0000, v88
    v_sub_f32 v20, v20, v18
    v_sub_f32 v21, v21, v18
    v_fma_f32 v19, v20, v20, v19
    v_fma_f32 v22, v21, v21, v22
    v_lshlrev_b32 v20, 16, v89
    v_and_b32 v21, 0xffff0000, v89
    v_sub_f32 v20, v20, v18
    v_sub_f32 v21, v21, v18
    v_fma_f32 v19, v20, v20, v19
    v_fma_f32 v22, v21, v21, v22
    v_lshlrev_b32 v20, 16, v90
    v_and_b32 v21, 0xffff0000, v90
    v_sub_f32 v20, v20, v18
    v_sub_f32 v21, v21, v18
    v_fma_f32 v19, v20, v20, v19
    v_fma_f32 v22, v21, v21, v22
    v_lshlrev_b32 v20, 16, v91
    v_and_b32 v21, 0xffff0000, v91
    v_sub_f32 v20, v20, v18
    v_sub_f32 v21, v21, v18
    v_fma_f32 v19, v20, v20, v19
    v_fma_f32 v22, v21, v21, v22
    v_lshlrev_b32 v20, 16, v92
    v_and_b32 v21, 0xffff0000, v92
    v_sub_f32 v20, v20, v18
    v_sub_f32 v21, v21, v18
    v_fma_f32 v19, v20, v20, v19
    v_fma_f32 v22, v21, v21, v22
    v_lshlrev_b32 v20, 16, v93
    v_and_b32 v21, 0xffff0000, v93
    v_sub_f32 v20, v20, v18
    v_sub_f32 v21, v21, v18
    v_fma_f32 v19, v20, v20, v19
    v_fma_f32 v22, v21, v21, v22
    v_lshlrev_b32 v20, 16, v94
    v_and_b32 v21, 0xffff0000, v94
    v_sub_f32 v20, v20, v18
    v_sub_f32 v21, v21, v18
    v_fma_f32 v19, v20, v20, v19
    v_fma_f32 v22, v21, v21, v22
    v_lshlrev_b32 v20, 16, v95
    v_and_b32 v21, 0xffff0000, v95
    v_sub_f32 v20, v20, v18
    v_sub_f32 v21, v21, v18
    v_fma_f32 v19, v20, v20, v19
    v_fma_f32 v22, v21, v21, v22
    v_lshlrev_b32 v20, 16, v96
    v_and_b32 v21, 0xffff0000, v96
    v_sub_f32 v20, v20, v18
    v_sub_f32 v21, v21, v18
    v_fma_f32 v19, v20, v20, v19
    v_fma_f32 v22, v21, v21, v22
    v_lshlrev_b32 v20, 16, v97
    v_and_b32 v21, 0xffff0000, v97
    v_sub_f32 v20, v20, v18
    v_sub_f32 v21, v21, v18
    v_fma_f32 v19, v20, v20, v19
    v_fma_f32 v22, v21, v21, v22
    v_lshlrev_b32 v20, 16, v98
    v_and_b32 v21, 0xffff0000, v98
    v_sub_f32 v20, v20, v18
    v_sub_f32 v21, v21, v18
    v_fma_f32 v19, v20, v20, v19
    v_fma_f32 v22, v21, v21, v22
    v_lshlrev_b32 v20, 16, v99
    v_and_b32 v21, 0xffff0000, v99
    v_sub_f32 v20, v20, v18
    v_sub_f32 v21, v21, v18
    v_fma_f32 v19, v20, v20, v19
    v_fma_f32 v22, v21, v21, v22
    v_lshlrev_b32 v20, 16, v100
    v_and_b32 v21, 0xffff0000, v100
    v_sub_f32 v20, v20, v18
    v_sub_f32 v21, v21, v18
    v_fma_f32 v19, v20, v20, v19
    v_fma_f32 v22, v21, v21, v22
    v_lshlrev_b32 v20, 16, v101
    v_and_b32 v21, 0xffff0000, v101
    v_sub_f32 v20, v20, v18
    v_sub_f32 v21, v21, v18
    v_fma_f32 v19, v20, v20, v19
    v_fma_f32 v22, v21, v21, v22
    v_lshlrev_b32 v20, 16, v102
    v_and_b32 v21, 0xffff0000, v102
    v_sub_f32 v20, v20, v18
    v_sub_f32 v21, v21, v18
    v_fma_f32 v19, v20, v20, v19
    v_fma_f32 v22, v21, v21, v22
    v_lshlrev_b32 v20, 16, v103
    v_and_b32 v21, 0xffff0000, v103
    v_sub_f32 v20, v20, v18
    v_sub_f32 v21, v21, v18
    v_fma_f32 v19, v20, v20, v19
    v_fma_f32 v22, v21, v21, v22
    v_lshlrev_b32 v20, 16, v104
    v_and_b32 v21, 0xffff0000, v104
    v_sub_f32 v20, v20, v18
    v_sub_f32 v21, v21, v18
    v_fma_f32 v19, v20, v20, v19
    v_fma_f32 v22, v21, v21, v22
    v_lshlrev_b32 v20, 16, v105
    v_and_b32 v21, 0xffff0000, v105
    v_sub_f32 v20, v20, v18
    v_sub_f32 v21, v21, v18
    v_fma_f32 v19, v20, v20, v19
    v_fma_f32 v22, v21, v21, v22
    v_lshlrev_b32 v20, 16, v106
    v_and_b32 v21, 0xffff0000, v106
    v_sub_f32 v20, v20, v18
    v_sub_f32 v21, v21, v18
    v_fma_f32 v19, v20, v20, v19
    v_fma_f32 v22, v21, v21, v22
    v_lshlrev_b32 v20, 16, v107
    v_and_b32 v21, 0xffff0000, v107
    v_sub_f32 v20, v20, v18
    v_sub_f32 v21, v21, v18
    v_fma_f32 v19, v20, v20, v19
    v_fma_f32 v22, v21, v21, v22
    v_lshlrev_b32 v20, 16, v108
    v_and_b32 v21, 0xffff0000, v108
    v_sub_f32 v20, v20, v18
    v_sub_f32 v21, v21, v18
    v_fma_f32 v19, v20, v20, v19
    v_fma_f32 v22, v21, v21, v22
    v_lshlrev_b32 v20, 16, v109
    v_and_b32 v21, 0xffff0000, v109
    v_sub_f32 v20, v20, v18
    v_sub_f32 v21, v21, v18
    v_fma_f32 v19, v20, v20, v19
    v_fma_f32 v22, v21, v21, v22
    v_lshlrev_b32 v20, 16, v110
    v_and_b32 v21, 0xffff0000, v110
    v_sub_f32 v20, v20, v18
    v_sub_f32 v21, v21, v18
    v_fma_f32 v19, v20, v20, v19
    v_fma_f32 v22, v21, v21, v22
    v_lshlrev_b32 v20, 16, v111
    v_and_b32 v21, 0xffff0000, v111
    v_sub_f32 v20, v20, v18
    v_sub_f32 v21, v21, v18
    v_fma_f32 v19, v20, v20, v19
    v_fma_f32 v22, v21, v21, v22
    v_add_f32 v19, v19, v22
    s_nop 1
    v_add_f32_dpp v19, v19, v19 quad_perm:[1,0,3,2] row_mask:0xf bank_mask:0xf
    s_nop 1
    v_add_f32_dpp v19, v19, v19 quad_perm:[2,3,0,1] row_mask:0xf bank_mask:0xf
    v_mul_f32 v19, 0x3b000000, v19
    v_cvt_pk_bf16_f32 v18, v18, v18
    v_lshlrev_b32 v18, 16, v18
    v_cvt_pk_bf16_f32 v19, v19, v19
    v_lshlrev_b32 v19, 16, v19
    v_add_f32 v19, 0x3727c5ac, v19
    v_cvt_pk_bf16_f32 v19, v19, v19
    v_lshlrev_b32 v19, 16, v19
    v_sqrt_f32 v19, v19
    s_nop 0
    v_cvt_pk_bf16_f32 v19, v19, v19
    v_lshlrev_b32 v19, 16, v19
    v_rcp_f32 v19, v19
    buffer_load_dwordx4 v[96:99], v4, s[12:15], 0 offen offset:0
    buffer_load_dwordx4 v[100:103], v4, s[12:15], 0 offen offset:16
    buffer_load_dwordx4 v[104:107], v4, s[12:15], 0 offen offset:128
    buffer_load_dwordx4 v[108:111], v4, s[12:15], 0 offen offset:144
    buffer_load_dwordx4 v[80:83], v7, s[16:19], s44 offen
    buffer_load_dwordx4 v[84:87], v7, s[16:19], s44 offen offset:16
    s_add_u32 s44, s44, 176128
    buffer_load_dwordx4 v[88:91], v7, s[16:19], s44 offen
    buffer_load_dwordx4 v[92:95], v7, s[16:19], s44 offen offset:16
    s_add_u32 s44, s44, 176128
    v_mov_b32 v48, 0
    v_mov_b32 v49, 0
    v_mov_b32 v50, 0
    v_mov_b32 v51, 0
    v_mov_b32 v52, 0
    v_mov_b32 v53, 0
    v_mov_b32 v54, 0
    v_mov_b32 v55, 0
    v_mov_b32 v56, 0
    v_mov_b32 v57, 0
    v_mov_b32 v58, 0
    v_mov_b32 v59, 0
    v_mov_b32 v60, 0
    v_mov_b32 v61, 0
    v_mov_b32 v62, 0
    v_mov_b32 v63, 0
    v_mov_b32 v64, 0
    v_mov_b32 v65, 0
    v_mov_b32 v66, 0
    v_mov_b32 v67, 0
    v_mov_b32 v68, 0
    v_mov_b32 v69, 0
    v_mov_b32 v70, 0
    v_mov_b32 v71, 0
    v_mov_b32 v72, 0
    v_mov_b32 v73, 0
    v_mov_b32 v74, 0
    v_mov_b32 v75, 0
    v_mov_b32 v76, 0
    v_mov_b32 v77, 0
    v_mov_b32 v78, 0
    v_mov_b32 v79, 0
    s_waitcnt vmcnt(6)
    v_lshlrev_b32 v20, 16, v96
    v_and_b32 v21, 0xffff0000, v96
    v_sub_f32 v20, v20, v18
    v_sub_f32 v21, v21, v18
    v_cvt_pk_bf16_f32 v22, v20, v21
    v_lshlrev_b32 v20, 16, v22
    v_and_b32 v21, 0xffff0000, v22
    v_mul_f32 v20, v20, v19
    v_mul_f32 v21, v21, v19
    v_cvt_pk_bf16_f32 v96, v20, v21
    v_lshlrev_b32 v20, 16, v97
    v_and_b32 v21, 0xffff0000, v97
    v_sub_f32 v20, v20, v18
    v_sub_f32 v21, v21, v18
    v_cvt_pk_bf16_f32 v22, v20, v21
    v_lshlrev_b32 v20, 16, v22
    v_and_b32 v21, 0xffff0000, v22
    v_mul_f32 v20, v20, v19
    v_mul_f32 v21, v21, v19
    v_cvt_pk_bf16_f32 v97, v20, v21
    v_lshlrev_b32 v20, 16, v98
    v_and_b32 v21, 0xffff0000, v98
    v_sub_f32 v20, v20, v18
    v_sub_f32 v21, v21, v18
    v_cvt_pk_bf16_f32 v22, v20, v21
    v_lshlrev_b32 v20, 16, v22
    v_and_b32 v21, 0xffff0000, v22
    v_mul_f32 v20, v20, v19
    v_mul_f32 v21, v21, v19
    v_cvt_pk_bf16_f32 v98, v20, v21
    v_lshlrev_b32 v20, 16, v99
    v_and_b32 v21, 0xffff0000, v99
    v_sub_f32 v20, v20, v18
    v_sub_f32 v21, v21, v18
    v_cvt_pk_bf16_f32 v22, v20, v21
    v_lshlrev_b32 v20, 16, v22
    v_and_b32 v21, 0xffff0000, v22
    v_mul_f32 v20, v20, v19
    v_mul_f32 v21, v21, v19
    v_cvt_pk_bf16_f32 v99, v20, v21
    v_lshlrev_b32 v20, 16, v100
    v_and_b32 v21, 0xffff0000, v100
    v_sub_f32 v20, v20, v18
    v_sub_f32 v21, v21, v18
    v_cvt_pk_bf16_f32 v22, v20, v21
    v_lshlrev_b32 v20, 16, v22
    v_and_b32 v21, 0xffff0000, v22
    v_mul_f32 v20, v20, v19
    v_mul_f32 v21, v21, v19
    v_cvt_pk_bf16_f32 v100, v20, v21
    v_lshlrev_b32 v20, 16, v101
    v_and_b32 v21, 0xffff0000, v101
    v_sub_f32 v20, v20, v18
    v_sub_f32 v21, v21, v18
    v_cvt_pk_bf16_f32 v22, v20, v21
    v_lshlrev_b32 v20, 16, v22
    v_and_b32 v21, 0xffff0000, v22
    v_mul_f32 v20, v20, v19
    v_mul_f32 v21, v21, v19
    v_cvt_pk_bf16_f32 v101, v20, v21
    v_lshlrev_b32 v20, 16, v102
    v_and_b32 v21, 0xffff0000, v102
    v_sub_f32 v20, v20, v18
    v_sub_f32 v21, v21, v18
    v_cvt_pk_bf16_f32 v22, v20, v21
    v_lshlrev_b32 v20, 16, v22
    v_and_b32 v21, 0xffff0000, v22
    v_mul_f32 v20, v20, v19
    v_mul_f32 v21, v21, v19
    v_cvt_pk_bf16_f32 v102, v20, v21
    v_lshlrev_b32 v20, 16, v103
    v_and_b32 v21, 0xffff0000, v103
    v_sub_f32 v20, v20, v18
    v_sub_f32 v21, v21, v18
    v_cvt_pk_bf16_f32 v22, v20, v21
    v_lshlrev_b32 v20, 16, v22
    v_and_b32 v21, 0xffff0000, v22
    v_mul_f32 v20, v20, v19
    v_mul_f32 v21, v21, v19
    v_cvt_pk_bf16_f32 v103, v20, v21
    s_waitcnt vmcnt(2)
    ds_write_b128 v8, v[96:99] offset:0
    ds_write_b128 v8, v[100:103] offset:16
    ds_write_b128 v9, v[80:83] offset:0
    ds_write_b128 v9, v[84:87] offset:16
    s_waitcnt lgkmcnt(0)
    s_barrier
    buffer_load_dwordx4 v[96:99], v4, s[12:15], 0 offen offset:256
    buffer_load_dwordx4 v[100:103], v4, s[12:15], 0 offen offset:272
    buffer_load_dwordx4 v[80:83], v7, s[16:19], s44 offen
    buffer_load_dwordx4 v[84:87], v7, s[16:19], s44 offen offset:16
    s_add_u32 s44, s44, 176128
    ds_read_b128 v[24:27], v14 offset:0
    ds_read_b64_tr_b16 v[28:29], v15 offset:0
    ds_read_b64_tr_b16 v[30:31], v15 offset:1280
    ds_read_b64_tr_b16 v[32:33], v15 offset:64
    ds_read_b64_tr_b16 v[34:35], v15 offset:1344
    ds_read_b128 v[36:39], v14 offset:32
    ds_read_b64_tr_b16 v[40:41], v15 offset:5120
    ds_read_b64_tr_b16 v[42:43], v15 offset:6400
    ds_read_b64_tr_b16 v[44:45], v15 offset:5184
    ds_read_b64_tr_b16 v[46:47], v15 offset:6464
    s_waitcnt vmcnt(6)
    v_lshlrev_b32 v20, 16, v104
    v_and_b32 v21, 0xffff0000, v104
    v_sub_f32 v20, v20, v18
    v_sub_f32 v21, v21, v18
    v_cvt_pk_bf16_f32 v22, v20, v21
    v_lshlrev_b32 v20, 16, v22
    v_and_b32 v21, 0xffff0000, v22
    v_mul_f32 v20, v20, v19
    v_mul_f32 v21, v21, v19
    v_cvt_pk_bf16_f32 v104, v20, v21
    v_lshlrev_b32 v20, 16, v105
    v_and_b32 v21, 0xffff0000, v105
    v_sub_f32 v20, v20, v18
    v_sub_f32 v21, v21, v18
    v_cvt_pk_bf16_f32 v22, v20, v21
    v_lshlrev_b32 v20, 16, v22
    v_and_b32 v21, 0xffff0000, v22
    v_mul_f32 v20, v20, v19
    v_mul_f32 v21, v21, v19
    v_cvt_pk_bf16_f32 v105, v20, v21
    v_lshlrev_b32 v20, 16, v106
    v_and_b32 v21, 0xffff0000, v106
    v_sub_f32 v20, v20, v18
    v_sub_f32 v21, v21, v18
    v_cvt_pk_bf16_f32 v22, v20, v21
    v_lshlrev_b32 v20, 16, v22
    v_and_b32 v21, 0xffff0000, v22
    v_mul_f32 v20, v20, v19
    v_mul_f32 v21, v21, v19
    v_cvt_pk_bf16_f32 v106, v20, v21
    v_lshlrev_b32 v20, 16, v107
    v_and_b32 v21, 0xffff0000, v107
    v_sub_f32 v20, v20, v18
    v_sub_f32 v21, v21, v18
    v_cvt_pk_bf16_f32 v22, v20, v21
    v_lshlrev_b32 v20, 16, v22
    v_and_b32 v21, 0xffff0000, v22
    v_mul_f32 v20, v20, v19
    v_mul_f32 v21, v21, v19
    v_cvt_pk_bf16_f32 v107, v20, v21
    v_lshlrev_b32 v20, 16, v108
    v_and_b32 v21, 0xffff0000, v108
    v_sub_f32 v20, v20, v18
    v_sub_f32 v21, v21, v18
    v_cvt_pk_bf16_f32 v22, v20, v21
    v_lshlrev_b32 v20, 16, v22
    v_and_b32 v21, 0xffff0000, v22
    v_mul_f32 v20, v20, v19
    v_mul_f32 v21, v21, v19
    v_cvt_pk_bf16_f32 v108, v20, v21
    v_lshlrev_b32 v20, 16, v109
    v_and_b32 v21, 0xffff0000, v109
    v_sub_f32 v20, v20, v18
    v_sub_f32 v21, v21, v18
    v_cvt_pk_bf16_f32 v22, v20, v21
    v_lshlrev_b32 v20, 16, v22
    v_and_b32 v21, 0xffff0000, v22
    v_mul_f32 v20, v20, v19
    v_mul_f32 v21, v21, v19
    v_cvt_pk_bf16_f32 v109, v20, v21
    v_lshlrev_b32 v20, 16, v110
    v_and_b32 v21, 0xffff0000, v110
    v_sub_f32 v20, v20, v18
    v_sub_f32 v21, v21, v18
    v_cvt_pk_bf16_f32 v22, v20, v21
    v_lshlrev_b32 v20, 16, v22
    v_and_b32 v21, 0xffff0000, v22
    v_mul_f32 v20, v20, v19
    v_mul_f32 v21, v21, v19
    v_cvt_pk_bf16_f32 v110, v20, v21
    v_lshlrev_b32 v20, 16, v111
    v_and_b32 v21, 0xffff0000, v111
    v_sub_f32 v20, v20, v18
    v_sub_f32 v21, v21, v18
    v_cvt_pk_bf16_f32 v22, v20, v21
    v_lshlrev_b32 v20, 16, v22
    v_and_b32 v21, 0xffff0000, v22
    v_mul_f32 v20, v20, v19
    v_mul_f32 v21, v21, v19
    v_cvt_pk_bf16_f32 v111, v20, v21
    s_waitcnt lgkmcnt(5)
    v_mfma_f32_32x32x16_bf16 v[48:63], v[24:27], v[28:31], v[48:63]
    v_mfma_f32_32x32x16_bf16 v[64:79], v[24:27], v[32:35], v[64:79]
    ds_read_b128 v[24:27], v14 offset:64
    ds_read_b64_tr_b16 v[28:29], v15 offset:10240
    ds_read_b64_tr_b16 v[30:31], v15 offset:11520
    ds_read_b64_tr_b16 v[32:33], v15 offset:10304
    ds_read_b64_tr_b16 v[34:35], v15 offset:11584
    s_waitcnt lgkmcnt(5)
    v_mfma_f32_32x32x16_bf16 v[48:63], v[36:39], v[40:43], v[48:63]
    v_mfma_f32_32x32x16_bf16 v[64:79], v[36:39], v[44:47], v[64:79]
    ds_read_b128 v[36:39], v14 offset:96
    ds_read_b64_tr_b16 v[40:41], v15 offset:15360
    ds_read_b64_tr_b16 v[42:43], v15 offset:16640
    ds_read_b64_tr_b16 v[44:45], v15 offset:15424
    ds_read_b64_tr_b16 v[46:47], v15 offset:16704
    s_waitcnt lgkmcnt(5)
    v_mfma_f32_32x32x16_bf16 v[48:63], v[24:27], v[28:31], v[48:63]
    v_mfma_f32_32x32x16_bf16 v[64:79], v[24:27], v[32:35], v[64:79]
    s_waitcnt lgkmcnt(0)
    v_mfma_f32_32x32x16_bf16 v[48:63], v[36:39], v[40:43], v[48:63]
    v_mfma_f32_32x32x16_bf16 v[64:79], v[36:39], v[44:47], v[64:79]
    s_waitcnt vmcnt(4)
    ds_write_b128 v8, v[104:107] offset:38912
    ds_write_b128 v8, v[108:111] offset:38928
    ds_write_b128 v9, v[88:91] offset:38912
    ds_write_b128 v9, v[92:95] offset:38928
    s_waitcnt lgkmcnt(0)
    s_barrier
    buffer_load_dwordx4 v[104:107], v4, s[12:15], 0 offen offset:384
    buffer_load_dwordx4 v[108:111], v4, s[12:15], 0 offen offset:400
    buffer_load_dwordx4 v[88:91], v7, s[16:19], s44 offen
    buffer_load_dwordx4 v[92:95], v7, s[16:19], s44 offen offset:16
    s_add_u32 s44, s44, 176128
    ds_read_b128 v[24:27], v14 offset:38912
    ds_read_b64_tr_b16 v[28:29], v15 offset:38912
    ds_read_b64_tr_b16 v[30:31], v15 offset:40192
    ds_read_b64_tr_b16 v[32:33], v15 offset:38976
    ds_read_b64_tr_b16 v[34:35], v15 offset:40256
    ds_read_b128 v[36:39], v14 offset:38944
    ds_read_b64_tr_b16 v[40:41], v15 offset:44032
    ds_read_b64_tr_b16 v[42:43], v15 offset:45312
    ds_read_b64_tr_b16 v[44:45], v15 offset:44096
    ds_read_b64_tr_b16 v[46:47], v15 offset:45376
    s_waitcnt vmcnt(6)
    v_lshlrev_b32 v20, 16, v96
    v_and_b32 v21, 0xffff0000, v96
    v_sub_f32 v20, v20, v18
    v_sub_f32 v21, v21, v18
    v_cvt_pk_bf16_f32 v22, v20, v21
    v_lshlrev_b32 v20, 16, v22
    v_and_b32 v21, 0xffff0000, v22
    v_mul_f32 v20, v20, v19
    v_mul_f32 v21, v21, v19
    v_cvt_pk_bf16_f32 v96, v20, v21
    v_lshlrev_b32 v20, 16, v97
    v_and_b32 v21, 0xffff0000, v97
    v_sub_f32 v20, v20, v18
    v_sub_f32 v21, v21, v18
    v_cvt_pk_bf16_f32 v22, v20, v21
    v_lshlrev_b32 v20, 16, v22
    v_and_b32 v21, 0xffff0000, v22
    v_mul_f32 v20, v20, v19
    v_mul_f32 v21, v21, v19
    v_cvt_pk_bf16_f32 v97, v20, v21
    v_lshlrev_b32 v20, 16, v98
    v_and_b32 v21, 0xffff0000, v98
    v_sub_f32 v20, v20, v18
    v_sub_f32 v21, v21, v18
    v_cvt_pk_bf16_f32 v22, v20, v21
    v_lshlrev_b32 v20, 16, v22
    v_and_b32 v21, 0xffff0000, v22
    v_mul_f32 v20, v20, v19
    v_mul_f32 v21, v21, v19
    v_cvt_pk_bf16_f32 v98, v20, v21
    v_lshlrev_b32 v20, 16, v99
    v_and_b32 v21, 0xffff0000, v99
    v_sub_f32 v20, v20, v18
    v_sub_f32 v21, v21, v18
    v_cvt_pk_bf16_f32 v22, v20, v21
    v_lshlrev_b32 v20, 16, v22
    v_and_b32 v21, 0xffff0000, v22
    v_mul_f32 v20, v20, v19
    v_mul_f32 v21, v21, v19
    v_cvt_pk_bf16_f32 v99, v20, v21
    v_lshlrev_b32 v20, 16, v100
    v_and_b32 v21, 0xffff0000, v100
    v_sub_f32 v20, v20, v18
    v_sub_f32 v21, v21, v18
    v_cvt_pk_bf16_f32 v22, v20, v21
    v_lshlrev_b32 v20, 16, v22
    v_and_b32 v21, 0xffff0000, v22
    v_mul_f32 v20, v20, v19
    v_mul_f32 v21, v21, v19
    v_cvt_pk_bf16_f32 v100, v20, v21
    v_lshlrev_b32 v20, 16, v101
    v_and_b32 v21, 0xffff0000, v101
    v_sub_f32 v20, v20, v18
    v_sub_f32 v21, v21, v18
    v_cvt_pk_bf16_f32 v22, v20, v21
    v_lshlrev_b32 v20, 16, v22
    v_and_b32 v21, 0xffff0000, v22
    v_mul_f32 v20, v20, v19
    v_mul_f32 v21, v21, v19
    v_cvt_pk_bf16_f32 v101, v20, v21
    v_lshlrev_b32 v20, 16, v102
    v_and_b32 v21, 0xffff0000, v102
    v_sub_f32 v20, v20, v18
    v_sub_f32 v21, v21, v18
    v_cvt_pk_bf16_f32 v22, v20, v21
    v_lshlrev_b32 v20, 16, v22
    v_and_b32 v21, 0xffff0000, v22
    v_mul_f32 v20, v20, v19
    v_mul_f32 v21, v21, v19
    v_cvt_pk_bf16_f32 v102, v20, v21
    v_lshlrev_b32 v20, 16, v103
    v_and_b32 v21, 0xffff0000, v103
    v_sub_f32 v20, v20, v18
    v_sub_f32 v21, v21, v18
    v_cvt_pk_bf16_f32 v22, v20, v21
    v_lshlrev_b32 v20, 16, v22
    v_and_b32 v21, 0xffff0000, v22
    v_mul_f32 v20, v20, v19
    v_mul_f32 v21, v21, v19
    v_cvt_pk_bf16_f32 v103, v20, v21
    s_waitcnt lgkmcnt(5)
    v_mfma_f32_32x32x16_bf16 v[48:63], v[24:27], v[28:31], v[48:63]
    v_mfma_f32_32x32x16_bf16 v[64:79], v[24:27], v[32:35], v[64:79]
    ds_read_b128 v[24:27], v14 offset:38976
    ds_read_b64_tr_b16 v[28:29], v15 offset:49152
    ds_read_b64_tr_b16 v[30:31], v15 offset:50432
    ds_read_b64_tr_b16 v[32:33], v15 offset:49216
    ds_read_b64_tr_b16 v[34:35], v15 offset:50496
    s_waitcnt lgkmcnt(5)
    v_mfma_f32_32x32x16_bf16 v[48:63], v[36:39], v[40:43], v[48:63]
    v_mfma_f32_32x32x16_bf16 v[64:79], v[36:39], v[44:47], v[64:79]
    ds_read_b128 v[36:39], v14 offset:39008
    ds_read_b64_tr_b16 v[40:41], v15 offset:54272
    ds_read_b64_tr_b16 v[42:43], v15 offset:55552
    ds_read_b64_tr_b16 v[44:45], v15 offset:54336
    ds_read_b64_tr_b16 v[46:47], v15 offset:55616
    s_waitcnt lgkmcnt(5)
    v_mfma_f32_32x32x16_bf16 v[48:63], v[24:27], v[28:31], v[48:63]
    v_mfma_f32_32x32x16_bf16 v[64:79], v[24:27], v[32:35], v[64:79]
    s_waitcnt lgkmcnt(0)
    v_mfma_f32_32x32x16_bf16 v[48:63], v[36:39], v[40:43], v[48:63]
    v_mfma_f32_32x32x16_bf16 v[64:79], v[36:39], v[44:47], v[64:79]
    s_waitcnt vmcnt(4)
    ds_write_b128 v8, v[96:99] offset:0
    ds_write_b128 v8, v[100:103] offset:16
    ds_write_b128 v9, v[80:83] offset:0
    ds_write_b128 v9, v[84:87] offset:16
    s_waitcnt lgkmcnt(0)
    s_barrier
    buffer_load_dwordx4 v[96:99], v4, s[12:15], 0 offen offset:512
    buffer_load_dwordx4 v[100:103], v4, s[12:15], 0 offen offset:528
    buffer_load_dwordx4 v[80:83], v7, s[16:19], s44 offen
    buffer_load_dwordx4 v[84:87], v7, s[16:19], s44 offen offset:16
    s_add_u32 s44, s44, 176128
    ds_read_b128 v[24:27], v14 offset:0
    ds_read_b64_tr_b16 v[28:29], v15 offset:0
    ds_read_b64_tr_b16 v[30:31], v15 offset:1280
    ds_read_b64_tr_b16 v[32:33], v15 offset:64
    ds_read_b64_tr_b16 v[34:35], v15 offset:1344
    ds_read_b128 v[36:39], v14 offset:32
    ds_read_b64_tr_b16 v[40:41], v15 offset:5120
    ds_read_b64_tr_b16 v[42:43], v15 offset:6400
    ds_read_b64_tr_b16 v[44:45], v15 offset:5184
    ds_read_b64_tr_b16 v[46:47], v15 offset:6464
    s_waitcnt vmcnt(6)
    v_lshlrev_b32 v20, 16, v104
    v_and_b32 v21, 0xffff0000, v104
    v_sub_f32 v20, v20, v18
    v_sub_f32 v21, v21, v18
    v_cvt_pk_bf16_f32 v22, v20, v21
    v_lshlrev_b32 v20, 16, v22
    v_and_b32 v21, 0xffff0000, v22
    v_mul_f32 v20, v20, v19
    v_mul_f32 v21, v21, v19
    v_cvt_pk_bf16_f32 v104, v20, v21
    v_lshlrev_b32 v20, 16, v105
    v_and_b32 v21, 0xffff0000, v105
    v_sub_f32 v20, v20, v18
    v_sub_f32 v21, v21, v18
    v_cvt_pk_bf16_f32 v22, v20, v21
    v_lshlrev_b32 v20, 16, v22
    v_and_b32 v21, 0xffff0000, v22
    v_mul_f32 v20, v20, v19
    v_mul_f32 v21, v21, v19
    v_cvt_pk_bf16_f32 v105, v20, v21
    v_lshlrev_b32 v20, 16, v106
    v_and_b32 v21, 0xffff0000, v106
    v_sub_f32 v20, v20, v18
    v_sub_f32 v21, v21, v18
    v_cvt_pk_bf16_f32 v22, v20, v21
    v_lshlrev_b32 v20, 16, v22
    v_and_b32 v21, 0xffff0000, v22
    v_mul_f32 v20, v20, v19
    v_mul_f32 v21, v21, v19
    v_cvt_pk_bf16_f32 v106, v20, v21
    v_lshlrev_b32 v20, 16, v107
    v_and_b32 v21, 0xffff0000, v107
    v_sub_f32 v20, v20, v18
    v_sub_f32 v21, v21, v18
    v_cvt_pk_bf16_f32 v22, v20, v21
    v_lshlrev_b32 v20, 16, v22
    v_and_b32 v21, 0xffff0000, v22
    v_mul_f32 v20, v20, v19
    v_mul_f32 v21, v21, v19
    v_cvt_pk_bf16_f32 v107, v20, v21
    v_lshlrev_b32 v20, 16, v108
    v_and_b32 v21, 0xffff0000, v108
    v_sub_f32 v20, v20, v18
    v_sub_f32 v21, v21, v18
    v_cvt_pk_bf16_f32 v22, v20, v21
    v_lshlrev_b32 v20, 16, v22
    v_and_b32 v21, 0xffff0000, v22
    v_mul_f32 v20, v20, v19
    v_mul_f32 v21, v21, v19
    v_cvt_pk_bf16_f32 v108, v20, v21
    v_lshlrev_b32 v20, 16, v109
    v_and_b32 v21, 0xffff0000, v109
    v_sub_f32 v20, v20, v18
    v_sub_f32 v21, v21, v18
    v_cvt_pk_bf16_f32 v22, v20, v21
    v_lshlrev_b32 v20, 16, v22
    v_and_b32 v21, 0xffff0000, v22
    v_mul_f32 v20, v20, v19
    v_mul_f32 v21, v21, v19
    v_cvt_pk_bf16_f32 v109, v20, v21
    v_lshlrev_b32 v20, 16, v110
    v_and_b32 v21, 0xffff0000, v110
    v_sub_f32 v20, v20, v18
    v_sub_f32 v21, v21, v18
    v_cvt_pk_bf16_f32 v22, v20, v21
    v_lshlrev_b32 v20, 16, v22
    v_and_b32 v21, 0xffff0000, v22
    v_mul_f32 v20, v20, v19
    v_mul_f32 v21, v21, v19
    v_cvt_pk_bf16_f32 v110, v20, v21
    v_lshlrev_b32 v20, 16, v111
    v_and_b32 v21, 0xffff0000, v111
    v_sub_f32 v20, v20, v18
    v_sub_f32 v21, v21, v18
    v_cvt_pk_bf16_f32 v22, v20, v21
    v_lshlrev_b32 v20, 16, v22
    v_and_b32 v21, 0xffff0000, v22
    v_mul_f32 v20, v20, v19
    v_mul_f32 v21, v21, v19
    v_cvt_pk_bf16_f32 v111, v20, v21
    s_waitcnt lgkmcnt(5)
    v_mfma_f32_32x32x16_bf16 v[48:63], v[24:27], v[28:31], v[48:63]
    v_mfma_f32_32x32x16_bf16 v[64:79], v[24:27], v[32:35], v[64:79]
    ds_read_b128 v[24:27], v14 offset:64
    ds_read_b64_tr_b16 v[28:29], v15 offset:10240
    ds_read_b64_tr_b16 v[30:31], v15 offset:11520
    ds_read_b64_tr_b16 v[32:33], v15 offset:10304
    ds_read_b64_tr_b16 v[34:35], v15 offset:11584
    s_waitcnt lgkmcnt(5)
    v_mfma_f32_32x32x16_bf16 v[48:63], v[36:39], v[40:43], v[48:63]
    v_mfma_f32_32x32x16_bf16 v[64:79], v[36:39], v[44:47], v[64:79]
    ds_read_b128 v[36:39], v14 offset:96
    ds_read_b64_tr_b16 v[40:41], v15 offset:15360
    ds_read_b64_tr_b16 v[42:43], v15 offset:16640
    ds_read_b64_tr_b16 v[44:45], v15 offset:15424
    ds_read_b64_tr_b16 v[46:47], v15 offset:16704
    s_waitcnt lgkmcnt(5)
    v_mfma_f32_32x32x16_bf16 v[48:63], v[24:27], v[28:31], v[48:63]
    v_mfma_f32_32x32x16_bf16 v[64:79], v[24:27], v[32:35], v[64:79]
    s_waitcnt lgkmcnt(0)
    v_mfma_f32_32x32x16_bf16 v[48:63], v[36:39], v[40:43], v[48:63]
    v_mfma_f32_32x32x16_bf16 v[64:79], v[36:39], v[44:47], v[64:79]
    s_waitcnt vmcnt(4)
    ds_write_b128 v8, v[104:107] offset:38912
    ds_write_b128 v8, v[108:111] offset:38928
    ds_write_b128 v9, v[88:91] offset:38912
    ds_write_b128 v9, v[92:95] offset:38928
    s_waitcnt lgkmcnt(0)
    s_barrier
    buffer_load_dwordx4 v[104:107], v4, s[12:15], 0 offen offset:640
    buffer_load_dwordx4 v[108:111], v4, s[12:15], 0 offen offset:656
    buffer_load_dwordx4 v[88:91], v7, s[16:19], s44 offen
    buffer_load_dwordx4 v[92:95], v7, s[16:19], s44 offen offset:16
    s_add_u32 s44, s44, 176128
    ds_read_b128 v[24:27], v14 offset:38912
    ds_read_b64_tr_b16 v[28:29], v15 offset:38912
    ds_read_b64_tr_b16 v[30:31], v15 offset:40192
    ds_read_b64_tr_b16 v[32:33], v15 offset:38976
    ds_read_b64_tr_b16 v[34:35], v15 offset:40256
    ds_read_b128 v[36:39], v14 offset:38944
    ds_read_b64_tr_b16 v[40:41], v15 offset:44032
    ds_read_b64_tr_b16 v[42:43], v15 offset:45312
    ds_read_b64_tr_b16 v[44:45], v15 offset:44096
    ds_read_b64_tr_b16 v[46:47], v15 offset:45376
    s_waitcnt vmcnt(6)
    v_lshlrev_b32 v20, 16, v96
    v_and_b32 v21, 0xffff0000, v96
    v_sub_f32 v20, v20, v18
    v_sub_f32 v21, v21, v18
    v_cvt_pk_bf16_f32 v22, v20, v21
    v_lshlrev_b32 v20, 16, v22
    v_and_b32 v21, 0xffff0000, v22
    v_mul_f32 v20, v20, v19
    v_mul_f32 v21, v21, v19
    v_cvt_pk_bf16_f32 v96, v20, v21
    v_lshlrev_b32 v20, 16, v97
    v_and_b32 v21, 0xffff0000, v97
    v_sub_f32 v20, v20, v18
    v_sub_f32 v21, v21, v18
    v_cvt_pk_bf16_f32 v22, v20, v21
    v_lshlrev_b32 v20, 16, v22
    v_and_b32 v21, 0xffff0000, v22
    v_mul_f32 v20, v20, v19
    v_mul_f32 v21, v21, v19
    v_cvt_pk_bf16_f32 v97, v20, v21
    v_lshlrev_b32 v20, 16, v98
    v_and_b32 v21, 0xffff0000, v98
    v_sub_f32 v20, v20, v18
    v_sub_f32 v21, v21, v18
    v_cvt_pk_bf16_f32 v22, v20, v21
    v_lshlrev_b32 v20, 16, v22
    v_and_b32 v21, 0xffff0000, v22
    v_mul_f32 v20, v20, v19
    v_mul_f32 v21, v21, v19
    v_cvt_pk_bf16_f32 v98, v20, v21
    v_lshlrev_b32 v20, 16, v99
    v_and_b32 v21, 0xffff0000, v99
    v_sub_f32 v20, v20, v18
    v_sub_f32 v21, v21, v18
    v_cvt_pk_bf16_f32 v22, v20, v21
    v_lshlrev_b32 v20, 16, v22
    v_and_b32 v21, 0xffff0000, v22
    v_mul_f32 v20, v20, v19
    v_mul_f32 v21, v21, v19
    v_cvt_pk_bf16_f32 v99, v20, v21
    v_lshlrev_b32 v20, 16, v100
    v_and_b32 v21, 0xffff0000, v100
    v_sub_f32 v20, v20, v18
    v_sub_f32 v21, v21, v18
    v_cvt_pk_bf16_f32 v22, v20, v21
    v_lshlrev_b32 v20, 16, v22
    v_and_b32 v21, 0xffff0000, v22
    v_mul_f32 v20, v20, v19
    v_mul_f32 v21, v21, v19
    v_cvt_pk_bf16_f32 v100, v20, v21
    v_lshlrev_b32 v20, 16, v101
    v_and_b32 v21, 0xffff0000, v101
    v_sub_f32 v20, v20, v18
    v_sub_f32 v21, v21, v18
    v_cvt_pk_bf16_f32 v22, v20, v21
    v_lshlrev_b32 v20, 16, v22
    v_and_b32 v21, 0xffff0000, v22
    v_mul_f32 v20, v20, v19
    v_mul_f32 v21, v21, v19
    v_cvt_pk_bf16_f32 v101, v20, v21
    v_lshlrev_b32 v20, 16, v102
    v_and_b32 v21, 0xffff0000, v102
    v_sub_f32 v20, v20, v18
    v_sub_f32 v21, v21, v18
    v_cvt_pk_bf16_f32 v22, v20, v21
    v_lshlrev_b32 v20, 16, v22
    v_and_b32 v21, 0xffff0000, v22
    v_mul_f32 v20, v20, v19
    v_mul_f32 v21, v21, v19
    v_cvt_pk_bf16_f32 v102, v20, v21
    v_lshlrev_b32 v20, 16, v103
    v_and_b32 v21, 0xffff0000, v103
    v_sub_f32 v20, v20, v18
    v_sub_f32 v21, v21, v18
    v_cvt_pk_bf16_f32 v22, v20, v21
    v_lshlrev_b32 v20, 16, v22
    v_and_b32 v21, 0xffff0000, v22
    v_mul_f32 v20, v20, v19
    v_mul_f32 v21, v21, v19
    v_cvt_pk_bf16_f32 v103, v20, v21
    s_waitcnt lgkmcnt(5)
    v_mfma_f32_32x32x16_bf16 v[48:63], v[24:27], v[28:31], v[48:63]
    v_mfma_f32_32x32x16_bf16 v[64:79], v[24:27], v[32:35], v[64:79]
    ds_read_b128 v[24:27], v14 offset:38976
    ds_read_b64_tr_b16 v[28:29], v15 offset:49152
    ds_read_b64_tr_b16 v[30:31], v15 offset:50432
    ds_read_b64_tr_b16 v[32:33], v15 offset:49216
    ds_read_b64_tr_b16 v[34:35], v15 offset:50496
    s_waitcnt lgkmcnt(5)
    v_mfma_f32_32x32x16_bf16 v[48:63], v[36:39], v[40:43], v[48:63]
    v_mfma_f32_32x32x16_bf16 v[64:79], v[36:39], v[44:47], v[64:79]
    ds_read_b128 v[36:39], v14 offset:39008
    ds_read_b64_tr_b16 v[40:41], v15 offset:54272
    ds_read_b64_tr_b16 v[42:43], v15 offset:55552
    ds_read_b64_tr_b16 v[44:45], v15 offset:54336
    ds_read_b64_tr_b16 v[46:47], v15 offset:55616
    s_waitcnt lgkmcnt(5)
    v_mfma_f32_32x32x16_bf16 v[48:63], v[24:27], v[28:31], v[48:63]
    v_mfma_f32_32x32x16_bf16 v[64:79], v[24:27], v[32:35], v[64:79]
    s_waitcnt lgkmcnt(0)
    v_mfma_f32_32x32x16_bf16 v[48:63], v[36:39], v[40:43], v[48:63]
    v_mfma_f32_32x32x16_bf16 v[64:79], v[36:39], v[44:47], v[64:79]
    s_waitcnt vmcnt(4)
    ds_write_b128 v8, v[96:99] offset:0
    ds_write_b128 v8, v[100:103] offset:16
    ds_write_b128 v9, v[80:83] offset:0
    ds_write_b128 v9, v[84:87] offset:16
    s_waitcnt lgkmcnt(0)
    s_barrier
    buffer_load_dwordx4 v[96:99], v4, s[12:15], 0 offen offset:768
    buffer_load_dwordx4 v[100:103], v4, s[12:15], 0 offen offset:784
    buffer_load_dwordx4 v[80:83], v7, s[16:19], s44 offen
    buffer_load_dwordx4 v[84:87], v7, s[16:19], s44 offen offset:16
    s_add_u32 s44, s44, 176128
    ds_read_b128 v[24:27], v14 offset:0
    ds_read_b64_tr_b16 v[28:29], v15 offset:0
    ds_read_b64_tr_b16 v[30:31], v15 offset:1280
    ds_read_b64_tr_b16 v[32:33], v15 offset:64
    ds_read_b64_tr_b16 v[34:35], v15 offset:1344
    ds_read_b128 v[36:39], v14 offset:32
    ds_read_b64_tr_b16 v[40:41], v15 offset:5120
    ds_read_b64_tr_b16 v[42:43], v15 offset:6400
    ds_read_b64_tr_b16 v[44:45], v15 offset:5184
    ds_read_b64_tr_b16 v[46:47], v15 offset:6464
    s_waitcnt vmcnt(6)
    v_lshlrev_b32 v20, 16, v104
    v_and_b32 v21, 0xffff0000, v104
    v_sub_f32 v20, v20, v18
    v_sub_f32 v21, v21, v18
    v_cvt_pk_bf16_f32 v22, v20, v21
    v_lshlrev_b32 v20, 16, v22
    v_and_b32 v21, 0xffff0000, v22
    v_mul_f32 v20, v20, v19
    v_mul_f32 v21, v21, v19
    v_cvt_pk_bf16_f32 v104, v20, v21
    v_lshlrev_b32 v20, 16, v105
    v_and_b32 v21, 0xffff0000, v105
    v_sub_f32 v20, v20, v18
    v_sub_f32 v21, v21, v18
    v_cvt_pk_bf16_f32 v22, v20, v21
    v_lshlrev_b32 v20, 16, v22
    v_and_b32 v21, 0xffff0000, v22
    v_mul_f32 v20, v20, v19
    v_mul_f32 v21, v21, v19
    v_cvt_pk_bf16_f32 v105, v20, v21
    v_lshlrev_b32 v20, 16, v106
    v_and_b32 v21, 0xffff0000, v106
    v_sub_f32 v20, v20, v18
    v_sub_f32 v21, v21, v18
    v_cvt_pk_bf16_f32 v22, v20, v21
    v_lshlrev_b32 v20, 16, v22
    v_and_b32 v21, 0xffff0000, v22
    v_mul_f32 v20, v20, v19
    v_mul_f32 v21, v21, v19
    v_cvt_pk_bf16_f32 v106, v20, v21
    v_lshlrev_b32 v20, 16, v107
    v_and_b32 v21, 0xffff0000, v107
    v_sub_f32 v20, v20, v18
    v_sub_f32 v21, v21, v18
    v_cvt_pk_bf16_f32 v22, v20, v21
    v_lshlrev_b32 v20, 16, v22
    v_and_b32 v21, 0xffff0000, v22
    v_mul_f32 v20, v20, v19
    v_mul_f32 v21, v21, v19
    v_cvt_pk_bf16_f32 v107, v20, v21
    v_lshlrev_b32 v20, 16, v108
    v_and_b32 v21, 0xffff0000, v108
    v_sub_f32 v20, v20, v18
    v_sub_f32 v21, v21, v18
    v_cvt_pk_bf16_f32 v22, v20, v21
    v_lshlrev_b32 v20, 16, v22
    v_and_b32 v21, 0xffff0000, v22
    v_mul_f32 v20, v20, v19
    v_mul_f32 v21, v21, v19
    v_cvt_pk_bf16_f32 v108, v20, v21
    v_lshlrev_b32 v20, 16, v109
    v_and_b32 v21, 0xffff0000, v109
    v_sub_f32 v20, v20, v18
    v_sub_f32 v21, v21, v18
    v_cvt_pk_bf16_f32 v22, v20, v21
    v_lshlrev_b32 v20, 16, v22
    v_and_b32 v21, 0xffff0000, v22
    v_mul_f32 v20, v20, v19
    v_mul_f32 v21, v21, v19
    v_cvt_pk_bf16_f32 v109, v20, v21
    v_lshlrev_b32 v20, 16, v110
    v_and_b32 v21, 0xffff0000, v110
    v_sub_f32 v20, v20, v18
    v_sub_f32 v21, v21, v18
    v_cvt_pk_bf16_f32 v22, v20, v21
    v_lshlrev_b32 v20, 16, v22
    v_and_b32 v21, 0xffff0000, v22
    v_mul_f32 v20, v20, v19
    v_mul_f32 v21, v21, v19
    v_cvt_pk_bf16_f32 v110, v20, v21
    v_lshlrev_b32 v20, 16, v111
    v_and_b32 v21, 0xffff0000, v111
    v_sub_f32 v20, v20, v18
    v_sub_f32 v21, v21, v18
    v_cvt_pk_bf16_f32 v22, v20, v21
    v_lshlrev_b32 v20, 16, v22
    v_and_b32 v21, 0xffff0000, v22
    v_mul_f32 v20, v20, v19
    v_mul_f32 v21, v21, v19
    v_cvt_pk_bf16_f32 v111, v20, v21
    s_waitcnt lgkmcnt(5)
    v_mfma_f32_32x32x16_bf16 v[48:63], v[24:27], v[28:31], v[48:63]
    v_mfma_f32_32x32x16_bf16 v[64:79], v[24:27], v[32:35], v[64:79]
    ds_read_b128 v[24:27], v14 offset:64
    ds_read_b64_tr_b16 v[28:29], v15 offset:10240
    ds_read_b64_tr_b16 v[30:31], v15 offset:11520
    ds_read_b64_tr_b16 v[32:33], v15 offset:10304
    ds_read_b64_tr_b16 v[34:35], v15 offset:11584
    s_waitcnt lgkmcnt(5)
    v_mfma_f32_32x32x16_bf16 v[48:63], v[36:39], v[40:43], v[48:63]
    v_mfma_f32_32x32x16_bf16 v[64:79], v[36:39], v[44:47], v[64:79]
    ds_read_b128 v[36:39], v14 offset:96
    ds_read_b64_tr_b16 v[40:41], v15 offset:15360
    ds_read_b64_tr_b16 v[42:43], v15 offset:16640
    ds_read_b64_tr_b16 v[44:45], v15 offset:15424
    ds_read_b64_tr_b16 v[46:47], v15 offset:16704
    s_waitcnt lgkmcnt(5)
    v_mfma_f32_32x32x16_bf16 v[48:63], v[24:27], v[28:31], v[48:63]
    v_mfma_f32_32x32x16_bf16 v[64:79], v[24:27], v[32:35], v[64:79]
    s_waitcnt lgkmcnt(0)
    v_mfma_f32_32x32x16_bf16 v[48:63], v[36:39], v[40:43], v[48:63]
    v_mfma_f32_32x32x16_bf16 v[64:79], v[36:39], v[44:47], v[64:79]
    s_waitcnt vmcnt(4)
    ds_write_b128 v8, v[104:107] offset:38912
    ds_write_b128 v8, v[108:111] offset:38928
    ds_write_b128 v9, v[88:91] offset:38912
    ds_write_b128 v9, v[92:95] offset:38928
    s_waitcnt lgkmcnt(0)
    s_barrier
    buffer_load_dwordx4 v[104:107], v4, s[12:15], 0 offen offset:896
    buffer_load_dwordx4 v[108:111], v4, s[12:15], 0 offen offset:912
    buffer_load_dwordx4 v[88:91], v7, s[16:19], s44 offen
    buffer_load_dwordx4 v[92:95], v7, s[16:19], s44 offen offset:16
    s_add_u32 s44, s44, 176128
    ds_read_b128 v[24:27], v14 offset:38912
    ds_read_b64_tr_b16 v[28:29], v15 offset:38912
    ds_read_b64_tr_b16 v[30:31], v15 offset:40192
    ds_read_b64_tr_b16 v[32:33], v15 offset:38976
    ds_read_b64_tr_b16 v[34:35], v15 offset:40256
    ds_read_b128 v[36:39], v14 offset:38944
    ds_read_b64_tr_b16 v[40:41], v15 offset:44032
    ds_read_b64_tr_b16 v[42:43], v15 offset:45312
    ds_read_b64_tr_b16 v[44:45], v15 offset:44096
    ds_read_b64_tr_b16 v[46:47], v15 offset:45376
    s_waitcnt vmcnt(6)
    v_lshlrev_b32 v20, 16, v96
    v_and_b32 v21, 0xffff0000, v96
    v_sub_f32 v20, v20, v18
    v_sub_f32 v21, v21, v18
    v_cvt_pk_bf16_f32 v22, v20, v21
    v_lshlrev_b32 v20, 16, v22
    v_and_b32 v21, 0xffff0000, v22
    v_mul_f32 v20, v20, v19
    v_mul_f32 v21, v21, v19
    v_cvt_pk_bf16_f32 v96, v20, v21
    v_lshlrev_b32 v20, 16, v97
    v_and_b32 v21, 0xffff0000, v97
    v_sub_f32 v20, v20, v18
    v_sub_f32 v21, v21, v18
    v_cvt_pk_bf16_f32 v22, v20, v21
    v_lshlrev_b32 v20, 16, v22
    v_and_b32 v21, 0xffff0000, v22
    v_mul_f32 v20, v20, v19
    v_mul_f32 v21, v21, v19
    v_cvt_pk_bf16_f32 v97, v20, v21
    v_lshlrev_b32 v20, 16, v98
    v_and_b32 v21, 0xffff0000, v98
    v_sub_f32 v20, v20, v18
    v_sub_f32 v21, v21, v18
    v_cvt_pk_bf16_f32 v22, v20, v21
    v_lshlrev_b32 v20, 16, v22
    v_and_b32 v21, 0xffff0000, v22
    v_mul_f32 v20, v20, v19
    v_mul_f32 v21, v21, v19
    v_cvt_pk_bf16_f32 v98, v20, v21
    v_lshlrev_b32 v20, 16, v99
    v_and_b32 v21, 0xffff0000, v99
    v_sub_f32 v20, v20, v18
    v_sub_f32 v21, v21, v18
    v_cvt_pk_bf16_f32 v22, v20, v21
    v_lshlrev_b32 v20, 16, v22
    v_and_b32 v21, 0xffff0000, v22
    v_mul_f32 v20, v20, v19
    v_mul_f32 v21, v21, v19
    v_cvt_pk_bf16_f32 v99, v20, v21
    v_lshlrev_b32 v20, 16, v100
    v_and_b32 v21, 0xffff0000, v100
    v_sub_f32 v20, v20, v18
    v_sub_f32 v21, v21, v18
    v_cvt_pk_bf16_f32 v22, v20, v21
    v_lshlrev_b32 v20, 16, v22
    v_and_b32 v21, 0xffff0000, v22
    v_mul_f32 v20, v20, v19
    v_mul_f32 v21, v21, v19
    v_cvt_pk_bf16_f32 v100, v20, v21
    v_lshlrev_b32 v20, 16, v101
    v_and_b32 v21, 0xffff0000, v101
    v_sub_f32 v20, v20, v18
    v_sub_f32 v21, v21, v18
    v_cvt_pk_bf16_f32 v22, v20, v21
    v_lshlrev_b32 v20, 16, v22
    v_and_b32 v21, 0xffff0000, v22
    v_mul_f32 v20, v20, v19
    v_mul_f32 v21, v21, v19
    v_cvt_pk_bf16_f32 v101, v20, v21
    v_lshlrev_b32 v20, 16, v102
    v_and_b32 v21, 0xffff0000, v102
    v_sub_f32 v20, v20, v18
    v_sub_f32 v21, v21, v18
    v_cvt_pk_bf16_f32 v22, v20, v21
    v_lshlrev_b32 v20, 16, v22
    v_and_b32 v21, 0xffff0000, v22
    v_mul_f32 v20, v20, v19
    v_mul_f32 v21, v21, v19
    v_cvt_pk_bf16_f32 v102, v20, v21
    v_lshlrev_b32 v20, 16, v103
    v_and_b32 v21, 0xffff0000, v103
    v_sub_f32 v20, v20, v18
    v_sub_f32 v21, v21, v18
    v_cvt_pk_bf16_f32 v22, v20, v21
    v_lshlrev_b32 v20, 16, v22
    v_and_b32 v21, 0xffff0000, v22
    v_mul_f32 v20, v20, v19
    v_mul_f32 v21, v21, v19
    v_cvt_pk_bf16_f32 v103, v20, v21
    s_waitcnt lgkmcnt(5)
    v_mfma_f32_32x32x16_bf16 v[48:63], v[24:27], v[28:31], v[48:63]
    v_mfma_f32_32x32x16_bf16 v[64:79], v[24:27], v[32:35], v[64:79]
    ds_read_b128 v[24:27], v14 offset:38976
    ds_read_b64_tr_b16 v[28:29], v15 offset:49152
    ds_read_b64_tr_b16 v[30:31], v15 offset:50432
    ds_read_b64_tr_b16 v[32:33], v15 offset:49216
    ds_read_b64_tr_b16 v[34:35], v15 offset:50496
    s_waitcnt lgkmcnt(5)
    v_mfma_f32_32x32x16_bf16 v[48:63], v[36:39], v[40:43], v[48:63]
    v_mfma_f32_32x32x16_bf16 v[64:79], v[36:39], v[44:47], v[64:79]
    ds_read_b128 v[36:39], v14 offset:39008
    ds_read_b64_tr_b16 v[40:41], v15 offset:54272
    ds_read_b64_tr_b16 v[42:43], v15 offset:55552
    ds_read_b64_tr_b16 v[44:45], v15 offset:54336
    ds_read_b64_tr_b16 v[46:47], v15 offset:55616
    s_waitcnt lgkmcnt(5)
    v_mfma_f32_32x32x16_bf16 v[48:63], v[24:27], v[28:31], v[48:63]
    v_mfma_f32_32x32x16_bf16 v[64:79], v[24:27], v[32:35], v[64:79]
    s_waitcnt lgkmcnt(0)
    v_mfma_f32_32x32x16_bf16 v[48:63], v[36:39], v[40:43], v[48:63]
    v_mfma_f32_32x32x16_bf16 v[64:79], v[36:39], v[44:47], v[64:79]
    s_waitcnt vmcnt(4)
    ds_write_b128 v8, v[96:99] offset:0
    ds_write_b128 v8, v[100:103] offset:16
    ds_write_b128 v9, v[80:83] offset:0
    ds_write_b128 v9, v[84:87] offset:16
    s_waitcnt lgkmcnt(0)
    s_barrier
    ds_read_b128 v[24:27], v14 offset:0
    ds_read_b64_tr_b16 v[28:29], v15 offset:0
    ds_read_b64_tr_b16 v[30:31], v15 offset:1280
    ds_read_b64_tr_b16 v[32:33], v15 offset:64
    ds_read_b64_tr_b16 v[34:35], v15 offset:1344
    ds_read_b128 v[36:39], v14 offset:32
    ds_read_b64_tr_b16 v[40:41], v15 offset:5120
    ds_read_b64_tr_b16 v[42:43], v15 offset:6400
    ds_read_b64_tr_b16 v[44:45], v15 offset:5184
    ds_read_b64_tr_b16 v[46:47], v15 offset:6464
    s_waitcnt vmcnt(0)
    v_lshlrev_b32 v20, 16, v104
    v_and_b32 v21, 0xffff0000, v104
    v_sub_f32 v20, v20, v18
    v_sub_f32 v21, v21, v18
    v_cvt_pk_bf16_f32 v22, v20, v21
    v_lshlrev_b32 v20, 16, v22
    v_and_b32 v21, 0xffff0000, v22
    v_mul_f32 v20, v20, v19
    v_mul_f32 v21, v21, v19
    v_cvt_pk_bf16_f32 v104, v20, v21
    v_lshlrev_b32 v20, 16, v105
    v_and_b32 v21, 0xffff0000, v105
    v_sub_f32 v20, v20, v18
    v_sub_f32 v21, v21, v18
    v_cvt_pk_bf16_f32 v22, v20, v21
    v_lshlrev_b32 v20, 16, v22
    v_and_b32 v21, 0xffff0000, v22
    v_mul_f32 v20, v20, v19
    v_mul_f32 v21, v21, v19
    v_cvt_pk_bf16_f32 v105, v20, v21
    v_lshlrev_b32 v20, 16, v106
    v_and_b32 v21, 0xffff0000, v106
    v_sub_f32 v20, v20, v18
    v_sub_f32 v21, v21, v18
    v_cvt_pk_bf16_f32 v22, v20, v21
    v_lshlrev_b32 v20, 16, v22
    v_and_b32 v21, 0xffff0000, v22
    v_mul_f32 v20, v20, v19
    v_mul_f32 v21, v21, v19
    v_cvt_pk_bf16_f32 v106, v20, v21
    v_lshlrev_b32 v20, 16, v107
    v_and_b32 v21, 0xffff0000, v107
    v_sub_f32 v20, v20, v18
    v_sub_f32 v21, v21, v18
    v_cvt_pk_bf16_f32 v22, v20, v21
    v_lshlrev_b32 v20, 16, v22
    v_and_b32 v21, 0xffff0000, v22
    v_mul_f32 v20, v20, v19
    v_mul_f32 v21, v21, v19
    v_cvt_pk_bf16_f32 v107, v20, v21
    v_lshlrev_b32 v20, 16, v108
    v_and_b32 v21, 0xffff0000, v108
    v_sub_f32 v20, v20, v18
    v_sub_f32 v21, v21, v18
    v_cvt_pk_bf16_f32 v22, v20, v21
    v_lshlrev_b32 v20, 16, v22
    v_and_b32 v21, 0xffff0000, v22
    v_mul_f32 v20, v20, v19
    v_mul_f32 v21, v21, v19
    v_cvt_pk_bf16_f32 v108, v20, v21
    v_lshlrev_b32 v20, 16, v109
    v_and_b32 v21, 0xffff0000, v109
    v_sub_f32 v20, v20, v18
    v_sub_f32 v21, v21, v18
    v_cvt_pk_bf16_f32 v22, v20, v21
    v_lshlrev_b32 v20, 16, v22
    v_and_b32 v21, 0xffff0000, v22
    v_mul_f32 v20, v20, v19
    v_mul_f32 v21, v21, v19
    v_cvt_pk_bf16_f32 v109, v20, v21
    v_lshlrev_b32 v20, 16, v110
    v_and_b32 v21, 0xffff0000, v110
    v_sub_f32 v20, v20, v18
    v_sub_f32 v21, v21, v18
    v_cvt_pk_bf16_f32 v22, v20, v21
    v_lshlrev_b32 v20, 16, v22
    v_and_b32 v21, 0xffff0000, v22
    v_mul_f32 v20, v20, v19
    v_mul_f32 v21, v21, v19
    v_cvt_pk_bf16_f32 v110, v20, v21
    v_lshlrev_b32 v20, 16, v111
    v_and_b32 v21, 0xffff0000, v111
    v_sub_f32 v20, v20, v18
    v_sub_f32 v21, v21, v18
    v_cvt_pk_bf16_f32 v22, v20, v21
    v_lshlrev_b32 v20, 16, v22
    v_and_b32 v21, 0xffff0000, v22
    v_mul_f32 v20, v20, v19
    v_mul_f32 v21, v21, v19
    v_cvt_pk_bf16_f32 v111, v20, v21
    s_waitcnt lgkmcnt(5)
    v_mfma_f32_32x32x16_bf16 v[48:63], v[24:27], v[28:31], v[48:63]
    v_mfma_f32_32x32x16_bf16 v[64:79], v[24:27], v[32:35], v[64:79]
    ds_read_b128 v[24:27], v14 offset:64
    ds_read_b64_tr_b16 v[28:29], v15 offset:10240
    ds_read_b64_tr_b16 v[30:31], v15 offset:11520
    ds_read_b64_tr_b16 v[32:33], v15 offset:10304
    ds_read_b64_tr_b16 v[34:35], v15 offset:11584
    s_waitcnt lgkmcnt(5)
    v_mfma_f32_32x32x16_bf16 v[48:63], v[36:39], v[40:43], v[48:63]
    v_mfma_f32_32x32x16_bf16 v[64:79], v[36:39], v[44:47], v[64:79]
    ds_read_b128 v[36:39], v14 offset:96
    ds_read_b64_tr_b16 v[40:41], v15 offset:15360
    ds_read_b64_tr_b16 v[42:43], v15 offset:16640
    ds_read_b64_tr_b16 v[44:45], v15 offset:15424
    ds_read_b64_tr_b16 v[46:47], v15 offset:16704
    s_waitcnt lgkmcnt(5)
    v_mfma_f32_32x32x16_bf16 v[48:63], v[24:27], v[28:31], v[48:63]
    v_mfma_f32_32x32x16_bf16 v[64:79], v[24:27], v[32:35], v[64:79]
    s_waitcnt lgkmcnt(0)
    v_mfma_f32_32x32x16_bf16 v[48:63], v[36:39], v[40:43], v[48:63]
    v_mfma_f32_32x32x16_bf16 v[64:79], v[36:39], v[44:47], v[64:79]
    s_waitcnt vmcnt(0)
    ds_write_b128 v8, v[104:107] offset:38912
    ds_write_b128 v8, v[108:111] offset:38928
    ds_write_b128 v9, v[88:91] offset:38912
    ds_write_b128 v9, v[92:95] offset:38928
    s_waitcnt lgkmcnt(0)
    s_barrier
    ds_read_b128 v[24:27], v14 offset:38912
    ds_read_b64_tr_b16 v[28:29], v15 offset:38912
    ds_read_b64_tr_b16 v[30:31], v15 offset:40192
    ds_read_b64_tr_b16 v[32:33], v15 offset:38976
    ds_read_b64_tr_b16 v[34:35], v15 offset:40256
    ds_read_b128 v[36:39], v14 offset:38944
    ds_read_b64_tr_b16 v[40:41], v15 offset:44032
    ds_read_b64_tr_b16 v[42:43], v15 offset:45312
    ds_read_b64_tr_b16 v[44:45], v15 offset:44096
    ds_read_b64_tr_b16 v[46:47], v15 offset:45376
    s_waitcnt lgkmcnt(5)
    v_mfma_f32_32x32x16_bf16 v[48:63], v[24:27], v[28:31], v[48:63]
    v_mfma_f32_32x32x16_bf16 v[64:79], v[24:27], v[32:35], v[64:79]
    ds_read_b128 v[24:27], v14 offset:38976
    ds_read_b64_tr_b16 v[28:29], v15 offset:49152
    ds_read_b64_tr_b16 v[30:31], v15 offset:50432
    ds_read_b64_tr_b16 v[32:33], v15 offset:49216
    ds_read_b64_tr_b16 v[34:35], v15 offset:50496
    s_waitcnt lgkmcnt(5)
    v_mfma_f32_32x32x16_bf16 v[48:63], v[36:39], v[40:43], v[48:63]
    v_mfma_f32_32x32x16_bf16 v[64:79], v[36:39], v[44:47], v[64:79]
    ds_read_b128 v[36:39], v14 offset:39008
    ds_read_b64_tr_b16 v[40:41], v15 offset:54272
    ds_read_b64_tr_b16 v[42:43], v15 offset:55552
    ds_read_b64_tr_b16 v[44:45], v15 offset:54336
    ds_read_b64_tr_b16 v[46:47], v15 offset:55616
    s_waitcnt lgkmcnt(5)
    v_mfma_f32_32x32x16_bf16 v[48:63], v[24:27], v[28:31], v[48:63]
    v_mfma_f32_32x32x16_bf16 v[64:79], v[24:27], v[32:35], v[64:79]
    s_waitcnt lgkmcnt(0)
    v_mfma_f32_32x32x16_bf16 v[48:63], v[36:39], v[40:43], v[48:63]
    v_mfma_f32_32x32x16_bf16 v[64:79], v[36:39], v[44:47], v[64:79]
    s_nop 15
    s_nop 7
    s_barrier
    v_lshrrev_b32 v2, 5, v10
    v_lshlrev_b32 v2, 2, v2
    v_lshl_add_u32 v2, v12, 5, v2
    v_mul_u32_u24 v2, 272, v2
    v_and_b32 v3, 31, v10
    v_lshl_add_u32 v3, v13, 6, v3
    v_lshl_add_u32 v2, v3, 1, v2
    v_cvt_pk_bf16_f32 v48, v48, v48
    v_lshlrev_b32 v48, 16, v48
    v_mul_f32 v20, 0xbfb8aa3b, v48
    v_exp_f32 v20, v20
    s_nop 0
    v_add_f32 v20, 1.0, v20
    v_rcp_f32 v20, v20
    s_nop 0
    v_mul_f32 v48, v48, v20
    v_cvt_pk_bf16_f32 v48, v48, v48
    ds_write_b16 v2, v48 offset:0
    v_cvt_pk_bf16_f32 v49, v49, v49
    v_lshlrev_b32 v49, 16, v49
    v_mul_f32 v20, 0xbfb8aa3b, v49
    v_exp_f32 v20, v20
    s_nop 0
    v_add_f32 v20, 1.0, v20
    v_rcp_f32 v20, v20
    s_nop 0
    v_mul_f32 v49, v49, v20
    v_cvt_pk_bf16_f32 v49, v49, v49
    ds_write_b16 v2, v49 offset:272
    v_cvt_pk_bf16_f32 v50, v50, v50
    v_lshlrev_b32 v50, 16, v50
    v_mul_f32 v20, 0xbfb8aa3b, v50
    v_exp_f32 v20, v20
    s_nop 0
    v_add_f32 v20, 1.0, v20
    v_rcp_f32 v20, v20
    s_nop 0
    v_mul_f32 v50, v50, v20
    v_cvt_pk_bf16_f32 v50, v50, v50
    ds_write_b16 v2, v50 offset:544
    v_cvt_pk_bf16_f32 v51, v51, v51
    v_lshlrev_b32 v51, 16, v51
    v_mul_f32 v20, 0xbfb8aa3b, v51
    v_exp_f32 v20, v20
    s_nop 0
    v_add_f32 v20, 1.0, v20
    v_rcp_f32 v20, v20
    s_nop 0
    v_mul_f32 v51, v51, v20
    v_cvt_pk_bf16_f32 v51, v51, v51
    ds_write_b16 v2, v51 offset:816
    v_cvt_pk_bf16_f32 v52, v52, v52
    v_lshlrev_b32 v52, 16, v52
    v_mul_f32 v20, 0xbfb8aa3b, v52
    v_exp_f32 v20, v20
    s_nop 0
    v_add_f32 v20, 1.0, v20
    v_rcp_f32 v20, v20
    s_nop 0
    v_mul_f32 v52, v52, v20
    v_cvt_pk_bf16_f32 v52, v52, v52
    ds_write_b16 v2, v52 offset:2176
    v_cvt_pk_bf16_f32 v53, v53, v53
    v_lshlrev_b32 v53, 16, v53
    v_mul_f32 v20, 0xbfb8aa3b, v53
    v_exp_f32 v20, v20
    s_nop 0
    v_add_f32 v20, 1.0, v20
    v_rcp_f32 v20, v20
    s_nop 0
    v_mul_f32 v53, v53, v20
    v_cvt_pk_bf16_f32 v53, v53, v53
    ds_write_b16 v2, v53 offset:2448
    v_cvt_pk_bf16_f32 v54, v54, v54
    v_lshlrev_b32 v54, 16, v54
    v_mul_f32 v20, 0xbfb8aa3b, v54
    v_exp_f32 v20, v20
    s_nop 0
    v_add_f32 v20, 1.0, v20
    v_rcp_f32 v20, v20
    s_nop 0
    v_mul_f32 v54, v54, v20
    v_cvt_pk_bf16_f32 v54, v54, v54
    ds_write_b16 v2, v54 offset:2720
    v_cvt_pk_bf16_f32 v55, v55, v55
    v_lshlrev_b32 v55, 16, v55
    v_mul_f32 v20, 0xbfb8aa3b, v55
    v_exp_f32 v20, v20
    s_nop 0
    v_add_f32 v20, 1.0, v20
    v_rcp_f32 v20, v20
    s_nop 0
    v_mul_f32 v55, v55, v20
    v_cvt_pk_bf16_f32 v55, v55, v55
    ds_write_b16 v2, v55 offset:2992
    v_cvt_pk_bf16_f32 v56, v56, v56
    v_lshlrev_b32 v56, 16, v56
    v_mul_f32 v20, 0xbfb8aa3b, v56
    v_exp_f32 v20, v20
    s_nop 0
    v_add_f32 v20, 1.0, v20
    v_rcp_f32 v20, v20
    s_nop 0
    v_mul_f32 v56, v56, v20
    v_cvt_pk_bf16_f32 v56, v56, v56
    ds_write_b16 v2, v56 offset:4352
    v_cvt_pk_bf16_f32 v57, v57, v57
    v_lshlrev_b32 v57, 16, v57
    v_mul_f32 v20, 0xbfb8aa3b, v57
    v_exp_f32 v20, v20
    s_nop 0
    v_add_f32 v20, 1.0, v20
    v_rcp_f32 v20, v20
    s_nop 0
    v_mul_f32 v57, v57, v20
    v_cvt_pk_bf16_f32 v57, v57, v57
    ds_write_b16 v2, v57 offset:4624
    v_cvt_pk_bf16_f32 v58, v58, v58
    v_lshlrev_b32 v58, 16, v58
    v_mul_f32 v20, 0xbfb8aa3b, v58
    v_exp_f32 v20, v20
    s_nop 0
    v_add_f32 v20, 1.0, v20
    v_rcp_f32 v20, v20
    s_nop 0
    v_mul_f32 v58, v58, v20
    v_cvt_pk_bf16_f32 v58, v58, v58
    ds_write_b16 v2, v58 offset:4896
    v_cvt_pk_bf16_f32 v59, v59, v59
    v_lshlrev_b32 v59, 16, v59
    v_mul_f32 v20, 0xbfb8aa3b, v59
    v_exp_f32 v20, v20
    s_nop 0
    v_add_f32 v20, 1.0, v20
    v_rcp_f32 v20, v20
    s_nop 0
    v_mul_f32 v59, v59, v20
    v_cvt_pk_bf16_f32 v59, v59, v59
    ds_write_b16 v2, v59 offset:5168
    v_cvt_pk_bf16_f32 v60, v60, v60
    v_lshlrev_b32 v60, 16, v60
    v_mul_f32 v20, 0xbfb8aa3b, v60
    v_exp_f32 v20, v20
    s_nop 0
    v_add_f32 v20, 1.0, v20
    v_rcp_f32 v20, v20
    s_nop 0
    v_mul_f32 v60, v60, v20
    v_cvt_pk_bf16_f32 v60, v60, v60
    ds_write_b16 v2, v60 offset:6528
    v_cvt_pk_bf16_f32 v61, v61, v61
    v_lshlrev_b32 v61, 16, v61
    v_mul_f32 v20, 0xbfb8aa3b, v61
    v_exp_f32 v20, v20
    s_nop 0
    v_add_f32 v20, 1.0, v20
    v_rcp_f32 v20, v20
    s_nop 0
    v_mul_f32 v61, v61, v20
    v_cvt_pk_bf16_f32 v61, v61, v61
    ds_write_b16 v2, v61 offset:6800
    v_cvt_pk_bf16_f32 v62, v62, v62
    v_lshlrev_b32 v62, 16, v62
    v_mul_f32 v20, 0xbfb8aa3b, v62
    v_exp_f32 v20, v20
    s_nop 0
    v_add_f32 v20, 1.0, v20
    v_rcp_f32 v20, v20
    s_nop 0
    v_mul_f32 v62, v62, v20
    v_cvt_pk_bf16_f32 v62, v62, v62
    ds_write_b16 v2, v62 offset:7072
    v_cvt_pk_bf16_f32 v63, v63, v63
    v_lshlrev_b32 v63, 16, v63
    v_mul_f32 v20, 0xbfb8aa3b, v63
    v_exp_f32 v20, v20
    s_nop 0
    v_add_f32 v20, 1.0, v20
    v_rcp_f32 v20, v20
    s_nop 0
    v_mul_f32 v63, v63, v20
    v_cvt_pk_bf16_f32 v63, v63, v63
    ds_write_b16 v2, v63 offset:7344
    v_cvt_pk_bf16_f32 v64, v64, v64
    v_lshlrev_b32 v64, 16, v64
    v_mul_f32 v20, 0xbfb8aa3b, v64
    v_exp_f32 v20, v20
    s_nop 0
    v_add_f32 v20, 1.0, v20
    v_rcp_f32 v20, v20
    s_nop 0
    v_mul_f32 v64, v64, v20
    v_cvt_pk_bf16_f32 v64, v64, v64
    ds_write_b16 v2, v64 offset:64
    v_cvt_pk_bf16_f32 v65, v65, v65
    v_lshlrev_b32 v65, 16, v65
    v_mul_f32 v20, 0xbfb8aa3b, v65
    v_exp_f32 v20, v20
    s_nop 0
    v_add_f32 v20, 1.0, v20
    v_rcp_f32 v20, v20
    s_nop 0
    v_mul_f32 v65, v65, v20
    v_cvt_pk_bf16_f32 v65, v65, v65
    ds_write_b16 v2, v65 offset:336
    v_cvt_pk_bf16_f32 v66, v66, v66
    v_lshlrev_b32 v66, 16, v66
    v_mul_f32 v20, 0xbfb8aa3b, v66
    v_exp_f32 v20, v20
    s_nop 0
    v_add_f32 v20, 1.0, v20
    v_rcp_f32 v20, v20
    s_nop 0
    v_mul_f32 v66, v66, v20
    v_cvt_pk_bf16_f32 v66, v66, v66
    ds_write_b16 v2, v66 offset:608
    v_cvt_pk_bf16_f32 v67, v67, v67
    v_lshlrev_b32 v67, 16, v67
    v_mul_f32 v20, 0xbfb8aa3b, v67
    v_exp_f32 v20, v20
    s_nop 0
    v_add_f32 v20, 1.0, v20
    v_rcp_f32 v20, v20
    s_nop 0
    v_mul_f32 v67, v67, v20
    v_cvt_pk_bf16_f32 v67, v67, v67
    ds_write_b16 v2, v67 offset:880
    v_cvt_pk_bf16_f32 v68, v68, v68
    v_lshlrev_b32 v68, 16, v68
    v_mul_f32 v20, 0xbfb8aa3b, v68
    v_exp_f32 v20, v20
    s_nop 0
    v_add_f32 v20, 1.0, v20
    v_rcp_f32 v20, v20
    s_nop 0
    v_mul_f32 v68, v68, v20
    v_cvt_pk_bf16_f32 v68, v68, v68
    ds_write_b16 v2, v68 offset:2240
    v_cvt_pk_bf16_f32 v69, v69, v69
    v_lshlrev_b32 v69, 16, v69
    v_mul_f32 v20, 0xbfb8aa3b, v69
    v_exp_f32 v20, v20
    s_nop 0
    v_add_f32 v20, 1.0, v20
    v_rcp_f32 v20, v20
    s_nop 0
    v_mul_f32 v69, v69, v20
    v_cvt_pk_bf16_f32 v69, v69, v69
    ds_write_b16 v2, v69 offset:2512
    v_cvt_pk_bf16_f32 v70, v70, v70
    v_lshlrev_b32 v70, 16, v70
    v_mul_f32 v20, 0xbfb8aa3b, v70
    v_exp_f32 v20, v20
    s_nop 0
    v_add_f32 v20, 1.0, v20
    v_rcp_f32 v20, v20
    s_nop 0
    v_mul_f32 v70, v70, v20
    v_cvt_pk_bf16_f32 v70, v70, v70
    ds_write_b16 v2, v70 offset:2784
    v_cvt_pk_bf16_f32 v71, v71, v71
    v_lshlrev_b32 v71, 16, v71
    v_mul_f32 v20, 0xbfb8aa3b, v71
    v_exp_f32 v20, v20
    s_nop 0
    v_add_f32 v20, 1.0, v20
    v_rcp_f32 v20, v20
    s_nop 0
    v_mul_f32 v71, v71, v20
    v_cvt_pk_bf16_f32 v71, v71, v71
    ds_write_b16 v2, v71 offset:3056
    v_cvt_pk_bf16_f32 v72, v72, v72
    v_lshlrev_b32 v72, 16, v72
    v_mul_f32 v20, 0xbfb8aa3b, v72
    v_exp_f32 v20, v20
    s_nop 0
    v_add_f32 v20, 1.0, v20
    v_rcp_f32 v20, v20
    s_nop 0
    v_mul_f32 v72, v72, v20
    v_cvt_pk_bf16_f32 v72, v72, v72
    ds_write_b16 v2, v72 offset:4416
    v_cvt_pk_bf16_f32 v73, v73, v73
    v_lshlrev_b32 v73, 16, v73
    v_mul_f32 v20, 0xbfb8aa3b, v73
    v_exp_f32 v20, v20
    s_nop 0
    v_add_f32 v20, 1.0, v20
    v_rcp_f32 v20, v20
    s_nop 0
    v_mul_f32 v73, v73, v20
    v_cvt_pk_bf16_f32 v73, v73, v73
    ds_write_b16 v2, v73 offset:4688
    v_cvt_pk_bf16_f32 v74, v74, v74
    v_lshlrev_b32 v74, 16, v74
    v_mul_f32 v20, 0xbfb8aa3b, v74
    v_exp_f32 v20, v20
    s_nop 0
    v_add_f32 v20, 1.0, v20
    v_rcp_f32 v20, v20
    s_nop 0
    v_mul_f32 v74, v74, v20
    v_cvt_pk_bf16_f32 v74, v74, v74
    ds_write_b16 v2, v74 offset:4960
    v_cvt_pk_bf16_f32 v75, v75, v75
    v_lshlrev_b32 v75, 16, v75
    v_mul_f32 v20, 0xbfb8aa3b, v75
    v_exp_f32 v20, v20
    s_nop 0
    v_add_f32 v20, 1.0, v20
    v_rcp_f32 v20, v20
    s_nop 0
    v_mul_f32 v75, v75, v20
    v_cvt_pk_bf16_f32 v75, v75, v75
    ds_write_b16 v2, v75 offset:5232
    v_cvt_pk_bf16_f32 v76, v76, v76
    v_lshlrev_b32 v76, 16, v76
    v_mul_f32 v20, 0xbfb8aa3b, v76
    v_exp_f32 v20, v20
    s_nop 0
    v_add_f32 v20, 1.0, v20
    v_rcp_f32 v20, v20
    s_nop 0
    v_mul_f32 v76, v76, v20
    v_cvt_pk_bf16_f32 v76, v76, v76
    ds_write_b16 v2, v76 offset:6592
    v_cvt_pk_bf16_f32 v77, v77, v77
    v_lshlrev_b32 v77, 16, v77
    v_mul_f32 v20, 0xbfb8aa3b, v77
    v_exp_f32 v20, v20
    s_nop 0
    v_add_f32 v20, 1.0, v20
    v_rcp_f32 v20, v20
    s_nop 0
    v_mul_f32 v77, v77, v20
    v_cvt_pk_bf16_f32 v77, v77, v77
    ds_write_b16 v2, v77 offset:6864
    v_cvt_pk_bf16_f32 v78, v78, v78
    v_lshlrev_b32 v78, 16, v78
    v_mul_f32 v20, 0xbfb8aa3b, v78
    v_exp_f32 v20, v20
    s_nop 0
    v_add_f32 v20, 1.0, v20
    v_rcp_f32 v20, v20
    s_nop 0
    v_mul_f32 v78, v78, v20
    v_cvt_pk_bf16_f32 v78, v78, v78
    ds_write_b16 v2, v78 offset:7136
    v_cvt_pk_bf16_f32 v79, v79, v79
    v_lshlrev_b32 v79, 16, v79
    v_mul_f32 v20, 0xbfb8aa3b, v79
    v_exp_f32 v20, v20
    s_nop 0
    v_add_f32 v20, 1.0, v20
    v_rcp_f32 v20, v20
    s_nop 0
    v_mul_f32 v79, v79, v20
    v_cvt_pk_bf16_f32 v79, v79, v79
    ds_write_b16 v2, v79 offset:7408
    s_waitcnt lgkmcnt(0)
    s_barrier
    v_lshrrev_b32 v2, 4, v0
    v_and_b32 v3, 15, v0
    v_mul_u32_u24 v4, 272, v2
    v_lshl_add_u32 v4, v3, 4, v4
    s_lshl_b32 s31, s29, 7
    v_add_u32 v2, s31, v2
    v_mul_lo_u32 v2, v2, s33
    s_lshl_b32 s34, s30, 7
    v_lshl_add_u32 v3, v3, 3, s34
    v_cmp_gt_u32 vcc, 1376, v3
    v_lshl_add_u32 v2, v3, 1, v2
    v_add_u32 v2, 16777216, v2
    s_and_saveexec_b64 s[36:37], vcc
    ds_read_b128 v[24:27], v4 offset:0
    s_waitcnt lgkmcnt(0)
    s_mov_b32 s38, 0
    buffer_store_dwordx4 v[24:27], v2, s[24:27], s38 offen
    ds_read_b128 v[24:27], v4 offset:8704
    s_waitcnt lgkmcnt(0)
    s_mov_b32 s38, 88064
    buffer_store_dwordx4 v[24:27], v2, s[24:27], s38 offen
    ds_read_b128 v[24:27], v4 offset:17408
    s_waitcnt lgkmcnt(0)
    s_mov_b32 s38, 176128
    buffer_store_dwordx4 v[24:27], v2, s[24:27], s38 offen
    ds_read_b128 v[24:27], v4 offset:26112
    s_waitcnt lgkmcnt(0)
    s_mov_b32 s38, 264192
    buffer_store_dwordx4 v[24:27], v2, s[24:27], s38 offen
    s_mov_b64 exec, s[36:37]
L_k1_kernel_end:
    s_endpgm
.globl k2_kernel
.p2align 8
.type k2_kernel,@function
k2_kernel:
    s_cmp_ge_u32 s2, 513
    s_cbranch_scc1 L_k2_kernel_end
    s_cmp_lt_u32 s2, 256
    s_cbranch_scc1 L_k2_gemm
    s_sub_u32 s2, s2, 256
    s_load_dwordx2 s[10:11], s[0:1], 64
    s_waitcnt lgkmcnt(0)
    s_mov_b32 s24, s10
    s_and_b32 s25, s11, 0xffff
    s_mov_b32 s26, 268435456
    s_mov_b32 s27, 0x00020000
    s_lshl_b32 s30, s2, 14
    v_lshlrev_b32 v2, 3, v0
    v_add_u32 v2, s30, v2
    s_mov_b32 s40, 0
    s_mov_b32 s41, 4096
    s_mov_b32 s42, 8192
    s_mov_b32 s43, 12288
    buffer_load_dwordx2 v[8:9], v2, s[24:27], s40 offen offset:0
    buffer_load_dwordx2 v[10:11], v2, s[24:27], s40 offen offset:2048
    buffer_load_dwordx2 v[12:13], v2, s[24:27], s41 offen offset:0
    buffer_load_dwordx2 v[14:15], v2, s[24:27], s41 offen offset:2048
    buffer_load_dwordx2 v[16:17], v2, s[24:27], s42 offen offset:0
    buffer_load_dwordx2 v[18:19], v2, s[24:27], s42 offen offset:2048
    buffer_load_dwordx2 v[20:21], v2, s[24:27], s43 offen offset:0
    buffer_load_dwordx2 v[22:23], v2, s[24:27], s43 offen offset:2048
    s_lshl_b32 s31, s2, 13
    s_add_u32 s31, s31, 8388608
    v_lshrrev_b32 v3, 6, v0
    v_bfe_u32 v4, v0, 3, 3
    v_lshl_add_u32 v3, v4, 3, v3
    v_and_b32 v4, 7, v0
    v_lshl_add_u32 v3, v4, 6, v3
    v_lshlrev_b32 v3, 2, v3
    v_add_u32 v3, s31, v3
    buffer_load_dword v24, v3, s[24:27], s40 offen offset:0
    buffer_load_dword v25, v3, s[24:27], s40 offen offset:2048
    buffer_load_dword v26, v3, s[24:27], s41 offen offset:0
    buffer_load_dword v27, v3, s[24:27], s41 offen offset:2048
    v_lshrrev_b32 v3, 6, v0
    v_add_u32 v3, 4, v3
    v_bfe_u32 v4, v0, 3, 3
    v_lshl_add_u32 v3, v4, 3, v3
    v_and_b32 v4, 7, v0
    v_lshl_add_u32 v3, v4, 6, v3
    v_lshlrev_b32 v3, 2, v3
    v_add_u32 v3, s31, v3
    buffer_load_dword v28, v3, s[24:27], s40 offen offset:0
    buffer_load_dword v29, v3, s[24:27], s40 offen offset:2048
    buffer_load_dword v30, v3, s[24:27], s41 offen offset:0
    buffer_load_dword v31, v3, s[24:27], s41 offen offset:2048
    v_cvt_f32_u32 v32, v0
    v_mul_f32 v33, 0.00048828125, v32
    v_cos_f32 v34, v33
    v_sin_f32 v35, v33
    s_nop 0
    v_sub_f32 v35, 0, v35
    v_mul_f32 v33, 0.0009765625, v32
    v_cos_f32 v36, v33
    v_sin_f32 v37, v33
    s_nop 0
    v_sub_f32 v37, 0, v37
    v_mul_f32 v33, 0.00146484375, v32
    v_cos_f32 v38, v33
    v_sin_f32 v39, v33
    s_nop 0
    v_sub_f32 v39, 0, v39
    v_mul_f32 v33, 0.001953125, v32
    v_cos_f32 v40, v33
    v_sin_f32 v41, v33
    s_nop 0
    v_sub_f32 v41, 0, v41
    v_mul_f32 v33, 0.00244140625, v32
    v_cos_f32 v42, v33
    v_sin_f32 v43, v33
    s_nop 0
    v_sub_f32 v43, 0, v43
    v_mul_f32 v33, 0.0029296875, v32
    v_cos_f32 v44, v33
    v_sin_f32 v45, v33
    s_nop 0
    v_sub_f32 v45, 0, v45
    v_mul_f32 v33, 0.00341796875, v32
    v_cos_f32 v46, v33
    v_sin_f32 v47, v33
    s_nop 0
    v_sub_f32 v47, 0, v47
    v_and_b32 v32, 31, v0
    v_cvt_f32_u32 v32, v32
    v_mul_f32 v33, 0.00390625, v32
    v_cos_f32 v48, v33
    v_sin_f32 v49, v33
    s_nop 0
    v_sub_f32 v49, 0, v49
    v_mul_f32 v33, 0.0078125, v32
    v_cos_f32 v50, v33
    v_sin_f32 v51, v33
    s_nop 0
    v_sub_f32 v51, 0, v51
    v_mul_f32 v33, 0.01171875, v32
    v_cos_f32 v52, v33
    v_sin_f32 v53, v33
    s_nop 0
    v_sub_f32 v53, 0, v53
    v_mul_f32 v33, 0.015625, v32
    v_cos_f32 v54, v33
    v_sin_f32 v55, v33
    s_nop 0
    v_sub_f32 v55, 0, v55
    v_mul_f32 v33, 0.01953125, v32
    v_cos_f32 v56, v33
    v_sin_f32 v57, v33
    s_nop 0
    v_sub_f32 v57, 0, v57
    v_mul_f32 v33, 0.0234375, v32
    v_cos_f32 v58, v33
    v_sin_f32 v59, v33
    s_nop 0
    v_sub_f32 v59, 0, v59
    v_mul_f32 v33, 0.02734375, v32
    v_cos_f32 v60, v33
    v_sin_f32 v61, v33
    s_nop 0
    v_sub_f32 v61, 0, v61
    v_and_b32 v32, 3, v0
    v_cvt_f32_u32 v32, v32
    v_mul_f32 v33, 0.03125, v32
    v_cos_f32 v62, v33
    v_sin_f32 v63, v33
    s_nop 0
    v_sub_f32 v63, 0, v63
    v_mul_f32 v33, 0.0625, v32
    v_cos_f32 v64, v33
    v_sin_f32 v65, v33
    s_nop 0
    v_sub_f32 v65, 0, v65
    v_mul_f32 v33, 0.09375, v32
    v_cos_f32 v66, v33
    v_sin_f32 v67, v33
    s_nop 0
    v_sub_f32 v67, 0, v67
    v_mul_f32 v33, 0.125, v32
    v_cos_f32 v68, v33
    v_sin_f32 v69, v33
    s_nop 0
    v_sub_f32 v69, 0, v69
    v_mul_f32 v33, 0.15625, v32
    v_cos_f32 v70, v33
    v_sin_f32 v71, v33
    s_nop 0
    v_sub_f32 v71, 0, v71
    v_mul_f32 v33, 0.1875, v32
    v_cos_f32 v72, v33
    v_sin_f32 v73, v33
    s_nop 0
    v_sub_f32 v73, 0, v73
    v_mul_f32 v33, 0.21875, v32
    v_cos_f32 v74, v33
    v_sin_f32 v75, v33
    s_nop 0
    v_sub_f32 v75, 0, v75
    v_lshrrev_b32 v3, 5, v0
    v_mul_u32_u24 v3, 36, v3
    v_and_b32 v4, 31, v0
    v_add_u32 v3, v3, v4
    v_lshlrev_b32 v32, 3, v3
    v_lshrrev_b32 v3, 5, v0
    v_mul_u32_u24 v3, 288, v3
    v_add_u32 v3, v3, v4
    v_lshlrev_b32 v33, 3, v3
    v_lshrrev_b32 v3, 5, v0
    v_mul_u32_u24 v3, 288, v3
    v_bfe_u32 v4, v0, 2, 3
    v_mul_u32_u24 v4, 36, v4
    v_add_u32 v3, v3, v4
    v_and_b32 v4, 3, v0
    v_add_u32 v3, v3, v4
    v_lshlrev_b32 v76, 3, v3
    v_lshrrev_b32 v3, 6, v0
    v_mul_u32_u24 v3, 288, v3
    v_bfe_u32 v4, v0, 3, 3
    v_mul_u32_u24 v4, 36, v4
    v_add_u32 v3, v3, v4
    v_and_b32 v4, 7, v0
    v_lshl_add_u32 v3, v4, 2, v3
    v_lshlrev_b32 v77, 3, v3
    v_add_u32 v78, 9216, v77
    s_waitcnt vmcnt(8)
    v_add_f32 v80, v8, v16
    v_add_f32 v81, v9, v17
    v_sub_f32 v82, v8, v16
    v_sub_f32 v83, v9, v17
    v_add_f32 v84, v10, v18
    v_add_f32 v85, v11, v19
    v_sub_f32 v86, v10, v18
    v_sub_f32 v87, v11, v19
    v_add_f32 v88, v12, v20
    v_add_f32 v89, v13, v21
    v_sub_f32 v90, v12, v20
    v_sub_f32 v91, v13, v21
    v_add_f32 v92, v14, v22
    v_add_f32 v93, v15, v23
    v_sub_f32 v94, v14, v22
    v_sub_f32 v95, v15, v23
    v_add_f32 v10, v86, v87
    v_sub_f32 v11, v87, v86
    v_mul_f32 v8, 0x3f3504f3, v10
    v_mul_f32 v9, 0x3f3504f3, v11
    v_mov_b32 v10, v91
    v_sub_f32 v11, 0, v90
    v_add_f32 v14, v94, v95
    v_sub_f32 v15, v95, v94
    v_mul_f32 v12, 0x3f3504f3, v15
    v_mul_f32 v13, 0xbf3504f3, v14
    v_add_f32 v14, v80, v88
    v_add_f32 v15, v81, v89
    v_sub_f32 v16, v80, v88
    v_sub_f32 v17, v81, v89
    v_add_f32 v18, v84, v92
    v_add_f32 v19, v85, v93
    v_sub_f32 v20, v84, v92
    v_sub_f32 v21, v85, v93
    v_add_f32 v22, v14, v18
    v_add_f32 v23, v15, v19
    v_sub_f32 v80, v14, v18
    v_sub_f32 v81, v15, v19
    v_add_f32 v84, v16, v21
    v_sub_f32 v85, v17, v20
    v_sub_f32 v86, v16, v21
    v_add_f32 v87, v17, v20
    v_add_f32 v14, v82, v10
    v_add_f32 v15, v83, v11
    v_sub_f32 v16, v82, v10
    v_sub_f32 v17, v83, v11
    v_add_f32 v18, v8, v12
    v_add_f32 v19, v9, v13
    v_sub_f32 v20, v8, v12
    v_sub_f32 v21, v9, v13
    v_add_f32 v8, v14, v18
    v_add_f32 v9, v15, v19
    v_sub_f32 v10, v14, v18
    v_sub_f32 v11, v15, v19
    v_add_f32 v12, v16, v21
    v_sub_f32 v13, v17, v20
    v_sub_f32 v82, v16, v21
    v_add_f32 v83, v17, v20
    v_mul_f32 v14, v8, v34
    v_mul_f32 v15, v9, v34
    v_fma_f32 v14, -v9, v35, v14
    v_fma_f32 v15, v8, v35, v15
    v_mul_f32 v8, v84, v36
    v_mul_f32 v9, v85, v36
    v_fma_f32 v8, -v85, v37, v8
    v_fma_f32 v9, v84, v37, v9
    v_mul_f32 v16, v12, v38
    v_mul_f32 v17, v13, v38
    v_fma_f32 v16, -v13, v39, v16
    v_fma_f32 v17, v12, v39, v17
    v_mul_f32 v12, v80, v40
    v_mul_f32 v13, v81, v40
    v_fma_f32 v12, -v81, v41, v12
    v_fma_f32 v13, v80, v41, v13
    v_mul_f32 v18, v10, v42
    v_mul_f32 v19, v11, v42
    v_fma_f32 v18, -v11, v43, v18
    v_fma_f32 v19, v10, v43, v19
    v_mul_f32 v10, v86, v44
    v_mul_f32 v11, v87, v44
    v_fma_f32 v10, -v87, v45, v10
    v_fma_f32 v11, v86, v45, v11
    v_mul_f32 v20, v82, v46
    v_mul_f32 v21, v83, v46
    v_fma_f32 v20, -v83, v47, v20
    v_fma_f32 v21, v82, v47, v21
    ds_write_b64 v32, v[22:23] offset:0
    ds_write_b64 v32, v[14:15] offset:2304
    ds_write_b64 v32, v[8:9] offset:4608
    ds_write_b64 v32, v[16:17] offset:6912
    ds_write_b64 v32, v[12:13] offset:9216
    ds_write_b64 v32, v[18:19] offset:11520
    ds_write_b64 v32, v[10:11] offset:13824
    ds_write_b64 v32, v[20:21] offset:16128
    s_waitcnt lgkmcnt(0)
    s_barrier
    ds_read_b64 v[8:9], v33 offset:0
    ds_read_b64 v[10:11], v33 offset:288
    ds_read_b64 v[12:13], v33 offset:576
    ds_read_b64 v[14:15], v33 offset:864
    ds_read_b64 v[16:17], v33 offset:1152
    ds_read_b64 v[18:19], v33 offset:1440
    ds_read_b64 v[20:21], v33 offset:1728
    ds_read_b64 v[22:23], v33 offset:2016
    s_waitcnt lgkmcnt(0)
    v_add_f32 v80, v8, v16
    v_add_f32 v81, v9, v17
    v_sub_f32 v82, v8, v16
    v_sub_f32 v83, v9, v17
    v_add_f32 v84, v10, v18
    v_add_f32 v85, v11, v19
    v_sub_f32 v86, v10, v18
    v_sub_f32 v87, v11, v19
    v_add_f32 v88, v12, v20
    v_add_f32 v89, v13, v21
    v_sub_f32 v90, v12, v20
    v_sub_f32 v91, v13, v21
    v_add_f32 v92, v14, v22
    v_add_f32 v93, v15, v23
    v_sub_f32 v94, v14, v22
    v_sub_f32 v95, v15, v23
    v_add_f32 v10, v86, v87
    v_sub_f32 v11, v87, v86
    v_mul_f32 v8, 0x3f3504f3, v10
    v_mul_f32 v9, 0x3f3504f3, v11
    v_mov_b32 v10, v91
    v_sub_f32 v11, 0, v90
    v_add_f32 v14, v94, v95
    v_sub_f32 v15, v95, v94
    v_mul_f32 v12, 0x3f3504f3, v15
    v_mul_f32 v13, 0xbf3504f3, v14
    v_add_f32 v14, v80, v88
    v_add_f32 v15, v81, v89
    v_sub_f32 v16, v80, v88
    v_sub_f32 v17, v81, v89
    v_add_f32 v18, v84, v92
    v_add_f32 v19, v85, v93
    v_sub_f32 v20, v84, v92
    v_sub_f32 v21, v85, v93
    v_add_f32 v22, v14, v18
    v_add_f32 v23, v15, v19
    v_sub_f32 v80, v14, v18
    v_sub_f32 v81, v15, v19
    v_add_f32 v84, v16, v21
    v_sub_f32 v85, v17, v20
    v_sub_f32 v86, v16, v21
    v_add_f32 v87, v17, v20
    v_add_f32 v14, v82, v10
    v_add_f32 v15, v83, v11
    v_sub_f32 v16, v82, v10
    v_sub_f32 v17, v83, v11
    v_add_f32 v18, v8, v12
    v_add_f32 v19, v9, v13
    v_sub_f32 v20, v8, v12
    v_sub_f32 v21, v9, v13
    v_add_f32 v8, v14, v18
    v_add_f32 v9, v15, v19
    v_sub_f32 v10, v14, v18
    v_sub_f32 v11, v15, v19
    v_add_f32 v12, v16, v21
    v_sub_f32 v13, v17, v20
    v_sub_f32 v82, v16, v21
    v_add_f32 v83, v17, v20
    v_mul_f32 v14, v8, v48
    v_mul_f32 v15, v9, v48
    v_fma_f32 v14, -v9, v49, v14
    v_fma_f32 v15, v8, v49, v15
    v_mul_f32 v8, v84, v50
    v_mul_f32 v9, v85, v50
    v_fma_f32 v8, -v85, v51, v8
    v_fma_f32 v9, v84, v51, v9
    v_mul_f32 v16, v12, v52
    v_mul_f32 v17, v13, v52
    v_fma_f32 v16, -v13, v53, v16
    v_fma_f32 v17, v12, v53, v17
    v_mul_f32 v12, v80, v54
    v_mul_f32 v13, v81, v54
    v_fma_f32 v12, -v81, v55, v12
    v_fma_f32 v13, v80, v55, v13
    v_mul_f32 v18, v10, v56
    v_mul_f32 v19, v11, v56
    v_fma_f32 v18, -v11, v57, v18
    v_fma_f32 v19, v10, v57, v19
    v_mul_f32 v10, v86, v58
    v_mul_f32 v11, v87, v58
    v_fma_f32 v10, -v87, v59, v10
    v_fma_f32 v11, v86, v59, v11
    v_mul_f32 v20, v82, v60
    v_mul_f32 v21, v83, v60
    v_fma_f32 v20, -v83, v61, v20
    v_fma_f32 v21, v82, v61, v21
    ds_write_b64 v33, v[22:23] offset:0
    ds_write_b64 v33, v[14:15] offset:288
    ds_write_b64 v33, v[8:9] offset:576
    ds_write_b64 v33, v[16:17] offset:864
    ds_write_b64 v33, v[12:13] offset:1152
    ds_write_b64 v33, v[18:19] offset:1440
    ds_write_b64 v33, v[10:11] offset:1728
    ds_write_b64 v33, v[20:21] offset:2016
    s_waitcnt lgkmcnt(0)
    s_barrier
    ds_read_b64 v[8:9], v76 offset:0
    ds_read_b64 v[10:11], v76 offset:32
    ds_read_b64 v[12:13], v76 offset:64
    ds_read_b64 v[14:15], v76 offset:96
    ds_read_b64 v[16:17], v76 offset:128
    ds_read_b64 v[18:19], v76 offset:160
    ds_read_b64 v[20:21], v76 offset:192
    ds_read_b64 v[22:23], v76 offset:224
    s_waitcnt lgkmcnt(0)
    v_add_f32 v80, v8, v16
    v_add_f32 v81, v9, v17
    v_sub_f32 v82, v8, v16
    v_sub_f32 v83, v9, v17
    v_add_f32 v84, v10, v18
    v_add_f32 v85, v11, v19
    v_sub_f32 v86, v10, v18
    v_sub_f32 v87, v11, v19
    v_add_f32 v88, v12, v20
    v_add_f32 v89, v13, v21
    v_sub_f32 v90, v12, v20
    v_sub_f32 v91, v13, v21
    v_add_f32 v92, v14, v22
    v_add_f32 v93, v15, v23
    v_sub_f32 v94, v14, v22
    v_sub_f32 v95, v15, v23
    v_add_f32 v10, v86, v87
    v_sub_f32 v11, v87, v86
    v_mul_f32 v8, 0x3f3504f3, v10
    v_mul_f32 v9, 0x3f3504f3, v11
    v_mov_b32 v10, v91
    v_sub_f32 v11, 0, v90
    v_add_f32 v14, v94, v95
    v_sub_f32 v15, v95, v94
    v_mul_f32 v12, 0x3f3504f3, v15
    v_mul_f32 v13, 0xbf3504f3, v14
    v_add_f32 v14, v80, v88
    v_add_f32 v15, v81, v89
    v_sub_f32 v16, v80, v88
    v_sub_f32 v17, v81, v89
    v_add_f32 v18, v84, v92
    v_add_f32 v19, v85, v93
    v_sub_f32 v20, v84, v92
    v_sub_f32 v21, v85, v93
    v_add_f32 v22, v14, v18
    v_add_f32 v23, v15, v19
    v_sub_f32 v80, v14, v18
    v_sub_f32 v81, v15, v19
    v_add_f32 v84, v16, v21
    v_sub_f32 v85, v17, v20
    v_sub_f32 v86, v16, v21
    v_add_f32 v87, v17, v20
    v_add_f32 v14, v82, v10
    v_add_f32 v15, v83, v11
    v_sub_f32 v16, v82, v10
    v_sub_f32 v17, v83, v11
    v_add_f32 v18, v8, v12
    v_add_f32 v19, v9, v13
    v_sub_f32 v20, v8, v12
    v_sub_f32 v21, v9, v13
    v_add_f32 v8, v14, v18
    v_add_f32 v9, v15, v19
    v_sub_f32 v10, v14, v18
    v_sub_f32 v11, v15, v19
    v_add_f32 v12, v16, v21
    v_sub_f32 v13, v17, v20
    v_sub_f32 v82, v16, v21
    v_add_f32 v83, v17, v20
    v_mul_f32 v14, v8, v62
    v_mul_f32 v15, v9, v62
    v_fma_f32 v14, -v9, v63, v14
    v_fma_f32 v15, v8, v63, v15
    v_mul_f32 v8, v84, v64
    v_mul_f32 v9, v85, v64
    v_fma_f32 v8, -v85, v65, v8
    v_fma_f32 v9, v84, v65, v9
    v_mul_f32 v16, v12, v66
    v_mul_f32 v17, v13, v66
    v_fma_f32 v16, -v13, v67, v16
    v_fma_f32 v17, v12, v67, v17
    v_mul_f32 v12, v80, v68
    v_mul_f32 v13, v81, v68
    v_fma_f32 v12, -v81, v69, v12
    v_fma_f32 v13, v80, v69, v13
    v_mul_f32 v18, v10, v70
    v_mul_f32 v19, v11, v70
    v_fma_f32 v18, -v11, v71, v18
    v_fma_f32 v19, v10, v71, v19
    v_mul_f32 v10, v86, v72
    v_mul_f32 v11, v87, v72
    v_fma_f32 v10, -v87, v73, v10
    v_fma_f32 v11, v86, v73, v11
    v_mul_f32 v20, v82, v74
    v_mul_f32 v21, v83, v74
    v_fma_f32 v20, -v83, v75, v20
    v_fma_f32 v21, v82, v75, v21
    ds_write_b64 v76, v[22:23] offset:0
    ds_write_b64 v76, v[14:15] offset:32
    ds_write_b64 v76, v[8:9] offset:64
    ds_write_b64 v76, v[16:17] offset:96
    ds_write_b64 v76, v[12:13] offset:128
    ds_write_b64 v76, v[18:19] offset:160
    ds_write_b64 v76, v[10:11] offset:192
    ds_write_b64 v76, v[20:21] offset:224
    s_waitcnt lgkmcnt(0)
    s_barrier
    s_waitcnt vmcnt(0)
    ds_read_b64 v[8:9], v77 offset:0
    ds_read_b64 v[10:11], v77 offset:8
    ds_read_b64 v[12:13], v77 offset:16
    ds_read_b64 v[14:15], v77 offset:24
    s_waitcnt lgkmcnt(0)
    v_add_f32 v16, v8, v12
    v_add_f32 v17, v9, v13
    v_sub_f32 v18, v8, v12
    v_sub_f32 v19, v9, v13
    v_add_f32 v20, v10, v14
    v_add_f32 v21, v11, v15
    v_sub_f32 v22, v10, v14
    v_sub_f32 v23, v11, v15
    v_add_f32 v8, v16, v20
    v_add_f32 v9, v17, v21
    v_sub_f32 v10, v16, v20
    v_sub_f32 v11, v17, v21
    v_add_f32 v12, v18, v23
    v_sub_f32 v13, v19, v22
    v_sub_f32 v14, v18, v23
    v_add_f32 v15, v19, v22
    v_lshlrev_b32 v16, 16, v24
    v_and_b32 v17, 0xffff0000, v24
    v_mul_f32 v16, 0x35000000, v16
    v_mul_f32 v17, 0x35000000, v17
    v_mul_f32 v18, v8, v16
    v_mul_f32 v19, v9, v16
    v_fma_f32 v18, -v9, v17, v18
    v_fma_f32 v19, v8, v17, v19
    v_lshlrev_b32 v8, 16, v25
    v_and_b32 v9, 0xffff0000, v25
    v_mul_f32 v8, 0x35000000, v8
    v_mul_f32 v9, 0x35000000, v9
    v_mul_f32 v16, v12, v8
    v_mul_f32 v17, v13, v8
    v_fma_f32 v16, -v13, v9, v16
    v_fma_f32 v17, v12, v9, v17
    v_lshlrev_b32 v8, 16, v26
    v_and_b32 v9, 0xffff0000, v26
    v_mul_f32 v8, 0x35000000, v8
    v_mul_f32 v9, 0x35000000, v9
    v_mul_f32 v12, v10, v8
    v_mul_f32 v13, v11, v8
    v_fma_f32 v12, -v11, v9, v12
    v_fma_f32 v13, v10, v9, v13
    v_lshlrev_b32 v8, 16, v27
    v_and_b32 v9, 0xffff0000, v27
    v_mul_f32 v8, 0x35000000, v8
    v_mul_f32 v9, 0x35000000, v9
    v_mul_f32 v10, v14, v8
    v_mul_f32 v11, v15, v8
    v_fma_f32 v10, -v15, v9, v10
    v_fma_f32 v11, v14, v9, v11
    v_add_f32 v8, v18, v12
    v_add_f32 v9, v19, v13
    v_sub_f32 v14, v18, v12
    v_sub_f32 v15, v19, v13
    v_add_f32 v20, v16, v10
    v_add_f32 v21, v17, v11
    v_sub_f32 v22, v16, v10
    v_sub_f32 v23, v17, v11
    v_add_f32 v10, v8, v20
    v_add_f32 v11, v9, v21
    v_sub_f32 v12, v8, v20
    v_sub_f32 v13, v9, v21
    v_sub_f32 v16, v14, v23
    v_add_f32 v17, v15, v22
    v_add_f32 v18, v14, v23
    v_sub_f32 v19, v15, v22
    ds_write_b64 v77, v[10:11] offset:0
    ds_write_b64 v77, v[16:17] offset:8
    ds_write_b64 v77, v[12:13] offset:16
    ds_write_b64 v77, v[18:19] offset:24
    ds_read_b64 v[8:9], v78 offset:0
    ds_read_b64 v[10:11], v78 offset:8
    ds_read_b64 v[12:13], v78 offset:16
    ds_read_b64 v[14:15], v78 offset:24
    s_waitcnt lgkmcnt(0)
    v_add_f32 v16, v8, v12
    v_add_f32 v17, v9, v13
    v_sub_f32 v18, v8, v12
    v_sub_f32 v19, v9, v13
    v_add_f32 v20, v10, v14
    v_add_f32 v21, v11, v15
    v_sub_f32 v22, v10, v14
    v_sub_f32 v23, v11, v15
    v_add_f32 v8, v16, v20
    v_add_f32 v9, v17, v21
    v_sub_f32 v10, v16, v20
    v_sub_f32 v11, v17, v21
    v_add_f32 v12, v18, v23
    v_sub_f32 v13, v19, v22
    v_sub_f32 v14, v18, v23
    v_add_f32 v15, v19, v22
    v_lshlrev_b32 v16, 16, v28
    v_and_b32 v17, 0xffff0000, v28
    v_mul_f32 v16, 0x35000000, v16
    v_mul_f32 v17, 0x35000000, v17
    v_mul_f32 v18, v8, v16
    v_mul_f32 v19, v9, v16
    v_fma_f32 v18, -v9, v17, v18
    v_fma_f32 v19, v8, v17, v19
    v_lshlrev_b32 v8, 16, v29
    v_and_b32 v9, 0xffff0000, v29
    v_mul_f32 v8, 0x35000000, v8
    v_mul_f32 v9, 0x35000000, v9
    v_mul_f32 v16, v12, v8
    v_mul_f32 v17, v13, v8
    v_fma_f32 v16, -v13, v9, v16
    v_fma_f32 v17, v12, v9, v17
    v_lshlrev_b32 v8, 16, v30
    v_and_b32 v9, 0xffff0000, v30
    v_mul_f32 v8, 0x35000000, v8
    v_mul_f32 v9, 0x35000000, v9
    v_mul_f32 v12, v10, v8
    v_mul_f32 v13, v11, v8
    v_fma_f32 v12, -v11, v9, v12
    v_fma_f32 v13, v10, v9, v13
    v_lshlrev_b32 v8, 16, v31
    v_and_b32 v9, 0xffff0000, v31
    v_mul_f32 v8, 0x35000000, v8
    v_mul_f32 v9, 0x35000000, v9
    v_mul_f32 v10, v14, v8
    v_mul_f32 v11, v15, v8
    v_fma_f32 v10, -v15, v9, v10
    v_fma_f32 v11, v14, v9, v11
    v_add_f32 v8, v18, v12
    v_add_f32 v9, v19, v13
    v_sub_f32 v14, v18, v12
    v_sub_f32 v15, v19, v13
    v_add_f32 v20, v16, v10
    v_add_f32 v21, v17, v11
    v_sub_f32 v22, v16, v10
    v_sub_f32 v23, v17, v11
    v_add_f32 v10, v8, v20
    v_add_f32 v11, v9, v21
    v_sub_f32 v12, v8, v20
    v_sub_f32 v13, v9, v21
    v_sub_f32 v16, v14, v23
    v_add_f32 v17, v15, v22
    v_add_f32 v18, v14, v23
    v_sub_f32 v19, v15, v22
    ds_write_b64 v78, v[10:11] offset:0
    ds_write_b64 v78, v[16:17] offset:8
    ds_write_b64 v78, v[12:13] offset:16
    ds_write_b64 v78, v[18:19] offset:24
    s_waitcnt lgkmcnt(0)
    s_barrier
    ds_read_b64 v[8:9], v76 offset:0
    ds_read_b64 v[10:11], v76 offset:32
    ds_read_b64 v[12:13], v76 offset:64
    ds_read_b64 v[14:15], v76 offset:96
    ds_read_b64 v[16:17], v76 offset:128
    ds_read_b64 v[18:19], v76 offset:160
    ds_read_b64 v[20:21], v76 offset:192
    ds_read_b64 v[22:23], v76 offset:224
    s_waitcnt lgkmcnt(0)
    v_mul_f32 v80, v10, v62
    v_mul_f32 v81, v11, v62
    v_fma_f32 v80, v11, v63, v80
    v_fma_f32 v81, -v10, v63, v81
    v_mul_f32 v10, v12, v64
    v_mul_f32 v11, v13, v64
    v_fma_f32 v10, v13, v65, v10
    v_fma_f32 v11, -v12, v65, v11
    v_mul_f32 v12, v14, v66
    v_mul_f32 v13, v15, v66
    v_fma_f32 v12, v15, v67, v12
    v_fma_f32 v13, -v14, v67, v13
    v_mul_f32 v14, v16, v68
    v_mul_f32 v15, v17, v68
    v_fma_f32 v14, v17, v69, v14
    v_fma_f32 v15, -v16, v69, v15
    v_mul_f32 v16, v18, v70
    v_mul_f32 v17, v19, v70
    v_fma_f32 v16, v19, v71, v16
    v_fma_f32 v17, -v18, v71, v17
    v_mul_f32 v18, v20, v72
    v_mul_f32 v19, v21, v72
    v_fma_f32 v18, v21, v73, v18
    v_fma_f32 v19, -v20, v73, v19
    v_mul_f32 v20, v22, v74
    v_mul_f32 v21, v23, v74
    v_fma_f32 v20, v23, v75, v20
    v_fma_f32 v21, -v22, v75, v21
    v_add_f32 v22, v8, v14
    v_add_f32 v23, v9, v15
    v_sub_f32 v82, v8, v14
    v_sub_f32 v83, v9, v15
    v_add_f32 v84, v80, v16
    v_add_f32 v85, v81, v17
    v_sub_f32 v86, v80, v16
    v_sub_f32 v87, v81, v17
    v_add_f32 v88, v10, v18
    v_add_f32 v89, v11, v19
    v_sub_f32 v90, v10, v18
    v_sub_f32 v91, v11, v19
    v_add_f32 v92, v12, v20
    v_add_f32 v93, v13, v21
    v_sub_f32 v94, v12, v20
    v_sub_f32 v95, v13, v21
    v_add_f32 v10, v86, v87
    v_sub_f32 v11, v87, v86
    v_mul_f32 v8, 0xbf3504f3, v11
    v_mul_f32 v9, 0x3f3504f3, v10
    v_sub_f32 v10, 0, v91
    v_mov_b32 v11, v90
    v_add_f32 v14, v94, v95
    v_sub_f32 v15, v95, v94
    v_mul_f32 v12, 0xbf3504f3, v14
    v_mul_f32 v13, 0xbf3504f3, v15
    v_add_f32 v14, v22, v88
    v_add_f32 v15, v23, v89
    v_sub_f32 v16, v22, v88
    v_sub_f32 v17, v23, v89
    v_add_f32 v18, v84, v92
    v_add_f32 v19, v85, v93
    v_sub_f32 v20, v84, v92
    v_sub_f32 v21, v85, v93
    v_add_f32 v22, v14, v18
    v_add_f32 v23, v15, v19
    v_sub_f32 v80, v14, v18
    v_sub_f32 v81, v15, v19
    v_sub_f32 v84, v16, v21
    v_add_f32 v85, v17, v20
    v_add_f32 v86, v16, v21
    v_sub_f32 v87, v17, v20
    v_add_f32 v14, v82, v10
    v_add_f32 v15, v83, v11
    v_sub_f32 v16, v82, v10
    v_sub_f32 v17, v83, v11
    v_add_f32 v18, v8, v12
    v_add_f32 v19, v9, v13
    v_sub_f32 v20, v8, v12
    v_sub_f32 v21, v9, v13
    v_add_f32 v8, v14, v18
    v_add_f32 v9, v15, v19
    v_sub_f32 v10, v14, v18
    v_sub_f32 v11, v15, v19
    v_sub_f32 v12, v16, v21
    v_add_f32 v13, v17, v20
    v_add_f32 v82, v16, v21
    v_sub_f32 v83, v17, v20
    ds_write_b64 v76, v[22:23] offset:0
    ds_write_b64 v76, v[8:9] offset:32
    ds_write_b64 v76, v[84:85] offset:64
    ds_write_b64 v76, v[12:13] offset:96
    ds_write_b64 v76, v[80:81] offset:128
    ds_write_b64 v76, v[10:11] offset:160
    ds_write_b64 v76, v[86:87] offset:192
    ds_write_b64 v76, v[82:83] offset:224
    s_waitcnt lgkmcnt(0)
    s_barrier
    ds_read_b64 v[8:9], v33 offset:0
    ds_read_b64 v[10:11], v33 offset:288
    ds_read_b64 v[12:13], v33 offset:576
    ds_read_b64 v[14:15], v33 offset:864
    ds_read_b64 v[16:17], v33 offset:1152
    ds_read_b64 v[18:19], v33 offset:1440
    ds_read_b64 v[20:21], v33 offset:1728
    ds_read_b64 v[22:23], v33 offset:2016
    s_waitcnt lgkmcnt(0)
    v_mul_f32 v80, v10, v48
    v_mul_f32 v81, v11, v48
    v_fma_f32 v80, v11, v49, v80
    v_fma_f32 v81, -v10, v49, v81
    v_mul_f32 v10, v12, v50
    v_mul_f32 v11, v13, v50
    v_fma_f32 v10, v13, v51, v10
    v_fma_f32 v11, -v12, v51, v11
    v_mul_f32 v12, v14, v52
    v_mul_f32 v13, v15, v52
    v_fma_f32 v12, v15, v53, v12
    v_fma_f32 v13, -v14, v53, v13
    v_mul_f32 v14, v16, v54
    v_mul_f32 v15, v17, v54
    v_fma_f32 v14, v17, v55, v14
    v_fma_f32 v15, -v16, v55, v15
    v_mul_f32 v16, v18, v56
    v_mul_f32 v17, v19, v56
    v_fma_f32 v16, v19, v57, v16
    v_fma_f32 v17, -v18, v57, v17
    v_mul_f32 v18, v20, v58
    v_mul_f32 v19, v21, v58
    v_fma_f32 v18, v21, v59, v18
    v_fma_f32 v19, -v20, v59, v19
    v_mul_f32 v20, v22, v60
    v_mul_f32 v21, v23, v60
    v_fma_f32 v20, v23, v61, v20
    v_fma_f32 v21, -v22, v61, v21
    v_add_f32 v22, v8, v14
    v_add_f32 v23, v9, v15
    v_sub_f32 v82, v8, v14
    v_sub_f32 v83, v9, v15
    v_add_f32 v84, v80, v16
    v_add_f32 v85, v81, v17
    v_sub_f32 v86, v80, v16
    v_sub_f32 v87, v81, v17
    v_add_f32 v88, v10, v18
    v_add_f32 v89, v11, v19
    v_sub_f32 v90, v10, v18
    v_sub_f32 v91, v11, v19
    v_add_f32 v92, v12, v20
    v_add_f32 v93, v13, v21
    v_sub_f32 v94, v12, v20
    v_sub_f32 v95, v13, v21
    v_add_f32 v10, v86, v87
    v_sub_f32 v11, v87, v86
    v_mul_f32 v8, 0xbf3504f3, v11
    v_mul_f32 v9, 0x3f3504f3, v10
    v_sub_f32 v10, 0, v91
    v_mov_b32 v11, v90
    v_add_f32 v14, v94, v95
    v_sub_f32 v15, v95, v94
    v_mul_f32 v12, 0xbf3504f3, v14
    v_mul_f32 v13, 0xbf3504f3, v15
    v_add_f32 v14, v22, v88
    v_add_f32 v15, v23, v89
    v_sub_f32 v16, v22, v88
    v_sub_f32 v17, v23, v89
    v_add_f32 v18, v84, v92
    v_add_f32 v19, v85, v93
    v_sub_f32 v20, v84, v92
    v_sub_f32 v21, v85, v93
    v_add_f32 v22, v14, v18
    v_add_f32 v23, v15, v19
    v_sub_f32 v80, v14, v18
    v_sub_f32 v81, v15, v19
    v_sub_f32 v84, v16, v21
    v_add_f32 v85, v17, v20
    v_add_f32 v86, v16, v21
    v_sub_f32 v87, v17, v20
    v_add_f32 v14, v82, v10
    v_add_f32 v15, v83, v11
    v_sub_f32 v16, v82, v10
    v_sub_f32 v17, v83, v11
    v_add_f32 v18, v8, v12
    v_add_f32 v19, v9, v13
    v_sub_f32 v20, v8, v12
    v_sub_f32 v21, v9, v13
    v_add_f32 v8, v14, v18
    v_add_f32 v9, v15, v19
    v_sub_f32 v10, v14, v18
    v_sub_f32 v11, v15, v19
    v_sub_f32 v12, v16, v21
    v_add_f32 v13, v17, v20
    v_add_f32 v82, v16, v21
    v_sub_f32 v83, v17, v20
    ds_write_b64 v33, v[22:23] offset:0
    ds_write_b64 v33, v[8:9] offset:288
    ds_write_b64 v33, v[84:85] offset:576
    ds_write_b64 v33, v[12:13] offset:864
    ds_write_b64 v33, v[80:81] offset:1152
    ds_write_b64 v33, v[10:11] offset:1440
    ds_write_b64 v33, v[86:87] offset:1728
    ds_write_b64 v33, v[82:83] offset:2016
    s_waitcnt lgkmcnt(0)
    s_barrier
    ds_read_b64 v[8:9], v32 offset:0
    ds_read_b64 v[10:11], v32 offset:2304
    ds_read_b64 v[12:13], v32 offset:4608
    ds_read_b64 v[14:15], v32 offset:6912
    ds_read_b64 v[16:17], v32 offset:9216
    ds_read_b64 v[18:19], v32 offset:11520
    ds_read_b64 v[20:21], v32 offset:13824
    ds_read_b64 v[22:23], v32 offset:16128
    s_waitcnt lgkmcnt(0)
    v_mul_f32 v80, v10, v34
    v_mul_f32 v81, v11, v34
    v_fma_f32 v80, v11, v35, v80
    v_fma_f32 v81, -v10, v35, v81
    v_mul_f32 v10, v12, v36
    v_mul_f32 v11, v13, v36
    v_fma_f32 v10, v13, v37, v10
    v_fma_f32 v11, -v12, v37, v11
    v_mul_f32 v12, v14, v38
    v_mul_f32 v13, v15, v38
    v_fma_f32 v12, v15, v39, v12
    v_fma_f32 v13, -v14, v39, v13
    v_mul_f32 v14, v16, v40
    v_mul_f32 v15, v17, v40
    v_fma_f32 v14, v17, v41, v14
    v_fma_f32 v15, -v16, v41, v15
    v_mul_f32 v16, v18, v42
    v_mul_f32 v17, v19, v42
    v_fma_f32 v16, v19, v43, v16
    v_fma_f32 v17, -v18, v43, v17
    v_mul_f32 v18, v20, v44
    v_mul_f32 v19, v21, v44
    v_fma_f32 v18, v21, v45, v18
    v_fma_f32 v19, -v20, v45, v19
    v_mul_f32 v20, v22, v46
    v_mul_f32 v21, v23, v46
    v_fma_f32 v20, v23, v47, v20
    v_fma_f32 v21, -v22, v47, v21
    v_add_f32 v22, v8, v14
    v_add_f32 v23, v9, v15
    v_sub_f32 v82, v8, v14
    v_sub_f32 v83, v9, v15
    v_add_f32 v84, v80, v16
    v_add_f32 v85, v81, v17
    v_sub_f32 v86, v80, v16
    v_sub_f32 v87, v81, v17
    v_add_f32 v88, v10, v18
    v_add_f32 v89, v11, v19
    v_sub_f32 v90, v10, v18
    v_sub_f32 v91, v11, v19
    v_add_f32 v92, v12, v20
    v_add_f32 v93, v13, v21
    v_sub_f32 v94, v12, v20
    v_sub_f32 v95, v13, v21
    v_add_f32 v10, v86, v87
    v_sub_f32 v11, v87, v86
    v_mul_f32 v8, 0xbf3504f3, v11
    v_mul_f32 v9, 0x3f3504f3, v10
    v_sub_f32 v10, 0, v91
    v_mov_b32 v11, v90
    v_add_f32 v14, v94, v95
    v_sub_f32 v15, v95, v94
    v_mul_f32 v12, 0xbf3504f3, v14
    v_mul_f32 v13, 0xbf3504f3, v15
    v_add_f32 v14, v22, v88
    v_add_f32 v15, v23, v89
    v_sub_f32 v16, v22, v88
    v_sub_f32 v17, v23, v89
    v_add_f32 v18, v84, v92
    v_add_f32 v19, v85, v93
    v_sub_f32 v20, v84, v92
    v_sub_f32 v21, v85, v93
    v_add_f32 v22, v14, v18
    v_add_f32 v23, v15, v19
    v_sub_f32 v80, v14, v18
    v_sub_f32 v81, v15, v19
    v_sub_f32 v84, v16, v21
    v_add_f32 v85, v17, v20
    v_add_f32 v86, v16, v21
    v_sub_f32 v87, v17, v20
    v_add_f32 v14, v82, v10
    v_add_f32 v15, v83, v11
    v_sub_f32 v16, v82, v10
    v_sub_f32 v17, v83, v11
    v_add_f32 v18, v8, v12
    v_add_f32 v19, v9, v13
    v_sub_f32 v20, v8, v12
    v_sub_f32 v21, v9, v13
    v_add_f32 v8, v14, v18
    v_add_f32 v9, v15, v19
    v_sub_f32 v10, v14, v18
    v_sub_f32 v11, v15, v19
    v_sub_f32 v12, v16, v21
    v_add_f32 v13, v17, v20
    v_add_f32 v82, v16, v21
    v_sub_f32 v83, v17, v20
    buffer_store_dwordx2 v[22:23], v2, s[24:27], s40 offen offset:0
    buffer_store_dwordx2 v[8:9], v2, s[24:27], s40 offen offset:2048
    buffer_store_dwordx2 v[84:85], v2, s[24:27], s41 offen offset:0
    buffer_store_dwordx2 v[12:13], v2, s[24:27], s41 offen offset:2048
    buffer_store_dwordx2 v[80:81], v2, s[24:27], s42 offen offset:0
    buffer_store_dwordx2 v[10:11], v2, s[24:27], s42 offen offset:2048
    buffer_store_dwordx2 v[86:87], v2, s[24:27], s43 offen offset:0
    buffer_store_dwordx2 v[82:83], v2, s[24:27], s43 offen offset:2048
    s_endpgm
L_k2_gemm:
    s_load_dwordx2 s[6:7], s[0:1], 40
    s_load_dwordx2 s[10:11], s[0:1], 64
    s_sub_u32 s28, s2, 0
    s_lshr_b32 s29, s28, 3
    s_and_b32 s30, s28, 7
    s_waitcnt lgkmcnt(0)
    s_mov_b32 s16, s6
    s_and_b32 s17, s7, 0xffff
    s_mov_b32 s18, 1409024
    s_mov_b32 s19, 0x00020000
    s_mov_b32 s24, s10
    s_and_b32 s25, s11, 0xffff
    s_mov_b32 s26, 268435456
    s_mov_b32 s27, 0x00020000
    v_lshrrev_b32 v2, 2, v0
    v_and_b32 v3, 3, v0
    s_lshl_b32 s31, s29, 6
    v_add_u32 v4, s31, v2
    s_mov_b32 s33, 2752
    v_mul_lo_u32 v4, v4, s33
    v_lshl_add_u32 v4, v3, 5, v4
    v_add_u32 v4, 16777216, v4
    v_lshlrev_b32 v7, 10, v2
    v_lshl_add_u32 v7, v3, 5, v7
    s_lshl_b32 s34, s30, 7
    v_add_u32 v7, s34, v7
    v_mul_u32_u24 v8, 144, v2
    v_lshl_add_u32 v8, v3, 5, v8
    v_mul_u32_u24 v9, 192, v2
    v_lshl_add_u32 v9, v3, 5, v9
    v_add_u32 v9, 9216, v9
    v_and_b32 v10, 63, v0
    v_lshrrev_b32 v11, 6, v0
    v_and_b32 v12, 1, v11
    v_lshrrev_b32 v13, 1, v11
    v_and_b32 v14, 31, v10
    v_lshl_add_u32 v14, v12, 5, v14
    v_mul_u32_u24 v14, 144, v14
    v_lshrrev_b32 v15, 5, v10
    v_lshl_add_u32 v14, v15, 4, v14
    v_lshlrev_b32 v15, 3, v15
    v_bfe_u32 v16, v10, 2, 2
    v_add_u32 v15, v15, v16
    v_mul_u32_u24 v15, 192, v15
    v_bfe_u32 v16, v10, 4, 1
    v_lshlrev_b32 v16, 5, v16
    v_and_b32 v17, 3, v10
    v_lshl_add_u32 v16, v17, 3, v16
    v_lshl_add_u32 v16, v13, 6, v16
    v_add_u32 v15, v15, v16
    v_add_u32 v15, 9216, v15
    v_mov_b32 v80, 0
    v_mov_b32 v81, 0
    v_mov_b32 v82, 0
    v_mov_b32 v83, 0
    v_mov_b32 v84, 0
    v_mov_b32 v85, 0
    v_mov_b32 v86, 0
    v_mov_b32 v87, 0
    v_mov_b32 v88, 0
    v_mov_b32 v89, 0
    v_mov_b32 v90, 0
    v_mov_b32 v91, 0
    v_mov_b32 v92, 0
    v_mov_b32 v93, 0
    v_mov_b32 v94, 0
    v_mov_b32 v95, 0
    s_mov_b32 s44, 0
    s_mov_b32 s45, 0
    buffer_load_dwordx4 v[48:51], v4, s[24:27], s44 offen
    buffer_load_dwordx4 v[52:55], v4, s[24:27], s44 offen offset:16
    buffer_load_dwordx4 v[56:59], v7, s[16:19], s45 offen
    buffer_load_dwordx4 v[60:63], v7, s[16:19], s45 offen offset:16
    s_add_u32 s44, s44, 128
    s_add_u32 s45, s45, 65536
    buffer_load_dwordx4 v[64:67], v4, s[24:27], s44 offen
    buffer_load_dwordx4 v[68:71], v4, s[24:27], s44 offen offset:16
    buffer_load_dwordx4 v[72:75], v7, s[16:19], s45 offen
    buffer_load_dwordx4 v[76:79], v7, s[16:19], s45 offen offset:16
    s_add_u32 s44, s44, 128
    s_add_u32 s45, s45, 65536
    s_waitcnt vmcnt(4)
    ds_write_b128 v8, v[48:51] offset:0
    ds_write_b128 v8, v[52:55] offset:16
    ds_write_b128 v9, v[56:59] offset:0
    ds_write_b128 v9, v[60:63] offset:16
    s_waitcnt lgkmcnt(0)
    s_barrier
    s_mov_b32 s46, 0
L_g2_loop:
    buffer_load_dwordx4 v[48:51], v4, s[24:27], s44 offen
    buffer_load_dwordx4 v[52:55], v4, s[24:27], s44 offen offset:16
    buffer_load_dwordx4 v[56:59], v7, s[16:19], s45 offen
    buffer_load_dwordx4 v[60:63], v7, s[16:19], s45 offen offset:16
    s_add_u32 s44, s44, 128
    s_add_u32 s45, s45, 65536
    ds_read_b128 v[24:27], v14 offset:0
    ds_read_b64_tr_b16 v[28:29], v15 offset:0
    ds_read_b64_tr_b16 v[30:31], v15 offset:768
    ds_read_b128 v[32:35], v14 offset:32
    ds_read_b64_tr_b16 v[36:37], v15 offset:3072
    ds_read_b64_tr_b16 v[38:39], v15 offset:3840
    s_waitcnt lgkmcnt(3)
    v_mfma_f32_32x32x16_bf16 v[80:95], v[24:27], v[28:31], v[80:95]
    ds_read_b128 v[24:27], v14 offset:64
    ds_read_b64_tr_b16 v[28:29], v15 offset:6144
    ds_read_b64_tr_b16 v[30:31], v15 offset:6912
    s_waitcnt lgkmcnt(3)
    v_mfma_f32_32x32x16_bf16 v[80:95], v[32:35], v[36:39], v[80:95]
    ds_read_b128 v[32:35], v14 offset:96
    ds_read_b64_tr_b16 v[36:37], v15 offset:9216
    ds_read_b64_tr_b16 v[38:39], v15 offset:9984
    s_waitcnt lgkmcnt(3)
    v_mfma_f32_32x32x16_bf16 v[80:95], v[24:27], v[28:31], v[80:95]
    s_waitcnt lgkmcnt(0)
    v_mfma_f32_32x32x16_bf16 v[80:95], v[32:35], v[36:39], v[80:95]
    s_waitcnt vmcnt(4)
    ds_write_b128 v8, v[64:67] offset:21504
    ds_write_b128 v8, v[68:71] offset:21520
    ds_write_b128 v9, v[72:75] offset:21504
    ds_write_b128 v9, v[76:79] offset:21520
    s_waitcnt lgkmcnt(0)
    s_barrier
    s_add_u32 s46, s46, 1
    s_cmp_eq_u32 s46, 11
    s_cbranch_scc1 L_g2_done
    buffer_load_dwordx4 v[64:67], v4, s[24:27], s44 offen
    buffer_load_dwordx4 v[68:71], v4, s[24:27], s44 offen offset:16
    buffer_load_dwordx4 v[72:75], v7, s[16:19], s45 offen
    buffer_load_dwordx4 v[76:79], v7, s[16:19], s45 offen offset:16
    s_add_u32 s44, s44, 128
    s_add_u32 s45, s45, 65536
    ds_read_b128 v[24:27], v14 offset:21504
    ds_read_b64_tr_b16 v[28:29], v15 offset:21504
    ds_read_b64_tr_b16 v[30:31], v15 offset:22272
    ds_read_b128 v[32:35], v14 offset:21536
    ds_read_b64_tr_b16 v[36:37], v15 offset:24576
    ds_read_b64_tr_b16 v[38:39], v15 offset:25344
    s_waitcnt lgkmcnt(3)
    v_mfma_f32_32x32x16_bf16 v[80:95], v[24:27], v[28:31], v[80:95]
    ds_read_b128 v[24:27], v14 offset:21568
    ds_read_b64_tr_b16 v[28:29], v15 offset:27648
    ds_read_b64_tr_b16 v[30:31], v15 offset:28416
    s_waitcnt lgkmcnt(3)
    v_mfma_f32_32x32x16_bf16 v[80:95], v[32:35], v[36:39], v[80:95]
    ds_read_b128 v[32:35], v14 offset:21600
    ds_read_b64_tr_b16 v[36:37], v15 offset:30720
    ds_read_b64_tr_b16 v[38:39], v15 offset:31488
    s_waitcnt lgkmcnt(3)
    v_mfma_f32_32x32x16_bf16 v[80:95], v[24:27], v[28:31], v[80:95]
    s_waitcnt lgkmcnt(0)
    v_mfma_f32_32x32x16_bf16 v[80:95], v[32:35], v[36:39], v[80:95]
    s_waitcnt vmcnt(4)
    ds_write_b128 v8, v[48:51] offset:0
    ds_write_b128 v8, v[52:55] offset:16
    ds_write_b128 v9, v[56:59] offset:0
    ds_write_b128 v9, v[60:63] offset:16
    s_waitcnt lgkmcnt(0)
    s_barrier
    s_branch L_g2_loop
L_g2_done:
    ds_read_b128 v[24:27], v14 offset:21504
    ds_read_b64_tr_b16 v[28:29], v15 offset:21504
    ds_read_b64_tr_b16 v[30:31], v15 offset:22272
    ds_read_b128 v[32:35], v14 offset:21536
    ds_read_b64_tr_b16 v[36:37], v15 offset:24576
    ds_read_b64_tr_b16 v[38:39], v15 offset:25344
    s_waitcnt lgkmcnt(3)
    v_mfma_f32_32x32x16_bf16 v[80:95], v[24:27], v[28:31], v[80:95]
    s_waitcnt lgkmcnt(0)
    v_mfma_f32_32x32x16_bf16 v[80:95], v[32:35], v[36:39], v[80:95]
    s_waitcnt vmcnt(0)
    s_nop 15
    s_nop 7
    s_mov_b32 s48, 8192
    s_mov_b32 s49, 16384
    s_mov_b32 s50, 24576
    v_lshrrev_b32 v2, 5, v10
    v_lshlrev_b32 v2, 2, v2
    v_lshl_add_u32 v2, v12, 5, v2
    v_add_u32 v2, s31, v2
    v_lshlrev_b32 v2, 10, v2
    v_and_b32 v3, 31, v10
    v_lshl_add_u32 v3, v13, 5, v3
    s_lshl_b32 s34, s30, 6
    v_add_u32 v3, s34, v3
    v_lshl_add_u32 v4, v3, 1, v2
    v_add_u32 v4, 25165824, v4
    v_cvt_pk_bf16_f32 v80, v80, v80
    v_lshlrev_b32 v80, 16, v80
    v_mul_f32 v20, 0xbfb8aa3b, v80
    v_exp_f32 v20, v20
    s_nop 0
    v_add_f32 v20, 1.0, v20
    v_rcp_f32 v20, v20
    s_nop 0
    v_mul_f32 v80, v80, v20
    v_cvt_pk_bf16_f32 v80, v80, v80
    buffer_store_short v80, v4, s[24:27], 0 offen offset:0
    v_cvt_pk_bf16_f32 v81, v81, v81
    v_lshlrev_b32 v81, 16, v81
    v_mul_f32 v20, 0xbfb8aa3b, v81
    v_exp_f32 v20, v20
    s_nop 0
    v_add_f32 v20, 1.0, v20
    v_rcp_f32 v20, v20
    s_nop 0
    v_mul_f32 v81, v81, v20
    v_cvt_pk_bf16_f32 v81, v81, v81
    buffer_store_short v81, v4, s[24:27], 0 offen offset:1024
    v_cvt_pk_bf16_f32 v82, v82, v82
    v_lshlrev_b32 v82, 16, v82
    v_mul_f32 v20, 0xbfb8aa3b, v82
    v_exp_f32 v20, v20
    s_nop 0
    v_add_f32 v20, 1.0, v20
    v_rcp_f32 v20, v20
    s_nop 0
    v_mul_f32 v82, v82, v20
    v_cvt_pk_bf16_f32 v82, v82, v82
    buffer_store_short v82, v4, s[24:27], 0 offen offset:2048
    v_cvt_pk_bf16_f32 v83, v83, v83
    v_lshlrev_b32 v83, 16, v83
    v_mul_f32 v20, 0xbfb8aa3b, v83
    v_exp_f32 v20, v20
    s_nop 0
    v_add_f32 v20, 1.0, v20
    v_rcp_f32 v20, v20
    s_nop 0
    v_mul_f32 v83, v83, v20
    v_cvt_pk_bf16_f32 v83, v83, v83
    buffer_store_short v83, v4, s[24:27], 0 offen offset:3072
    v_cvt_pk_bf16_f32 v84, v84, v84
    v_lshlrev_b32 v84, 16, v84
    v_mul_f32 v20, 0xbfb8aa3b, v84
    v_exp_f32 v20, v20
    s_nop 0
    v_add_f32 v20, 1.0, v20
    v_rcp_f32 v20, v20
    s_nop 0
    v_mul_f32 v84, v84, v20
    v_cvt_pk_bf16_f32 v84, v84, v84
    buffer_store_short v84, v4, s[24:27], s48 offen offset:0
    v_cvt_pk_bf16_f32 v85, v85, v85
    v_lshlrev_b32 v85, 16, v85
    v_mul_f32 v20, 0xbfb8aa3b, v85
    v_exp_f32 v20, v20
    s_nop 0
    v_add_f32 v20, 1.0, v20
    v_rcp_f32 v20, v20
    s_nop 0
    v_mul_f32 v85, v85, v20
    v_cvt_pk_bf16_f32 v85, v85, v85
    buffer_store_short v85, v4, s[24:27], s48 offen offset:1024
    v_cvt_pk_bf16_f32 v86, v86, v86
    v_lshlrev_b32 v86, 16, v86
    v_mul_f32 v20, 0xbfb8aa3b, v86
    v_exp_f32 v20, v20
    s_nop 0
    v_add_f32 v20, 1.0, v20
    v_rcp_f32 v20, v20
    s_nop 0
    v_mul_f32 v86, v86, v20
    v_cvt_pk_bf16_f32 v86, v86, v86
    buffer_store_short v86, v4, s[24:27], s48 offen offset:2048
    v_cvt_pk_bf16_f32 v87, v87, v87
    v_lshlrev_b32 v87, 16, v87
    v_mul_f32 v20, 0xbfb8aa3b, v87
    v_exp_f32 v20, v20
    s_nop 0
    v_add_f32 v20, 1.0, v20
    v_rcp_f32 v20, v20
    s_nop 0
    v_mul_f32 v87, v87, v20
    v_cvt_pk_bf16_f32 v87, v87, v87
    buffer_store_short v87, v4, s[24:27], s48 offen offset:3072
    v_cvt_pk_bf16_f32 v88, v88, v88
    v_lshlrev_b32 v88, 16, v88
    v_mul_f32 v20, 0xbfb8aa3b, v88
    v_exp_f32 v20, v20
    s_nop 0
    v_add_f32 v20, 1.0, v20
    v_rcp_f32 v20, v20
    s_nop 0
    v_mul_f32 v88, v88, v20
    v_cvt_pk_bf16_f32 v88, v88, v88
    buffer_store_short v88, v4, s[24:27], s49 offen offset:0
    v_cvt_pk_bf16_f32 v89, v89, v89
    v_lshlrev_b32 v89, 16, v89
    v_mul_f32 v20, 0xbfb8aa3b, v89
    v_exp_f32 v20, v20
    s_nop 0
    v_add_f32 v20, 1.0, v20
    v_rcp_f32 v20, v20
    s_nop 0
    v_mul_f32 v89, v89, v20
    v_cvt_pk_bf16_f32 v89, v89, v89
    buffer_store_short v89, v4, s[24:27], s49 offen offset:1024
    v_cvt_pk_bf16_f32 v90, v90, v90
    v_lshlrev_b32 v90, 16, v90
    v_mul_f32 v20, 0xbfb8aa3b, v90
    v_exp_f32 v20, v20
    s_nop 0
    v_add_f32 v20, 1.0, v20
    v_rcp_f32 v20, v20
    s_nop 0
    v_mul_f32 v90, v90, v20
    v_cvt_pk_bf16_f32 v90, v90, v90
    buffer_store_short v90, v4, s[24:27], s49 offen offset:2048
    v_cvt_pk_bf16_f32 v91, v91, v91
    v_lshlrev_b32 v91, 16, v91
    v_mul_f32 v20, 0xbfb8aa3b, v91
    v_exp_f32 v20, v20
    s_nop 0
    v_add_f32 v20, 1.0, v20
    v_rcp_f32 v20, v20
    s_nop 0
    v_mul_f32 v91, v91, v20
    v_cvt_pk_bf16_f32 v91, v91, v91
    buffer_store_short v91, v4, s[24:27], s49 offen offset:3072
    v_cvt_pk_bf16_f32 v92, v92, v92
    v_lshlrev_b32 v92, 16, v92
    v_mul_f32 v20, 0xbfb8aa3b, v92
    v_exp_f32 v20, v20
    s_nop 0
    v_add_f32 v20, 1.0, v20
    v_rcp_f32 v20, v20
    s_nop 0
    v_mul_f32 v92, v92, v20
    v_cvt_pk_bf16_f32 v92, v92, v92
    buffer_store_short v92, v4, s[24:27], s50 offen offset:0
    v_cvt_pk_bf16_f32 v93, v93, v93
    v_lshlrev_b32 v93, 16, v93
    v_mul_f32 v20, 0xbfb8aa3b, v93
    v_exp_f32 v20, v20
    s_nop 0
    v_add_f32 v20, 1.0, v20
    v_rcp_f32 v20, v20
    s_nop 0
    v_mul_f32 v93, v93, v20
    v_cvt_pk_bf16_f32 v93, v93, v93
    buffer_store_short v93, v4, s[24:27], s50 offen offset:1024
    v_cvt_pk_bf16_f32 v94, v94, v94
    v_lshlrev_b32 v94, 16, v94
    v_mul_f32 v20, 0xbfb8aa3b, v94
    v_exp_f32 v20, v20
    s_nop 0
    v_add_f32 v20, 1.0, v20
    v_rcp_f32 v20, v20
    s_nop 0
    v_mul_f32 v94, v94, v20
    v_cvt_pk_bf16_f32 v94, v94, v94
    buffer_store_short v94, v4, s[24:27], s50 offen offset:2048
    v_cvt_pk_bf16_f32 v95, v95, v95
    v_lshlrev_b32 v95, 16, v95
    v_mul_f32 v20, 0xbfb8aa3b, v95
    v_exp_f32 v20, v20
    s_nop 0
    v_add_f32 v20, 1.0, v20
    v_rcp_f32 v20, v20
    s_nop 0
    v_mul_f32 v95, v95, v20
    v_cvt_pk_bf16_f32 v95, v95, v95
    buffer_store_short v95, v4, s[24:27], s50 offen offset:3072
L_k2_kernel_end:
    s_endpgm
.globl k3_kernel
.p2align 8
.type k3_kernel,@function
k3_kernel:
    s_cmp_ge_u32 s2, 256
    s_cbranch_scc1 L_k3_kernel_end
    s_load_dwordx2 s[4:5], s[0:1], 0
    s_load_dwordx2 s[6:7], s[0:1], 48
    s_load_dwordx2 s[10:11], s[0:1], 64
    v_and_b32 v1, 63, v0
    v_lshrrev_b32 v2, 6, v0
    s_nop 0
    v_readfirstlane_b32 s28, v2
    s_lshl_b32 s29, s2, 3
    s_add_u32 s29, s29, s28
    s_waitcnt lgkmcnt(0)
    s_mov_b32 s12, s4
    s_and_b32 s13, s5, 0xffff
    s_mov_b32 s14, 2097152
    s_mov_b32 s15, 0x00020000
    s_mov_b32 s16, s6
    s_and_b32 s17, s7, 0xffff
    s_mov_b32 s18, 2097152
    s_mov_b32 s19, 0x00020000
    s_mov_b32 s24, s10
    s_and_b32 s25, s11, 0xffff
    s_mov_b32 s26, 268435456
    s_mov_b32 s27, 0x00020000
    v_lshrrev_b32 v2, 2, v0
    v_and_b32 v3, 3, v0
    v_lshlrev_b32 v6, 14, v2
    v_lshlrev_b32 v5, 4, v3
    s_lshl_b32 s35, s2, 6
    v_add3_u32 v6, v6, v5, s35
    v_mul_u32_u24 v4, 4128, v3
    v_lshl_add_u32 v4, v2, 3, v4
    v_add_u32 v4, 16384, v4
    buffer_load_dwordx4 v[8:11], v6, s[24:27], 0 offen
    v_add_u32 v6, 0x200000, v6
    buffer_load_dwordx4 v[12:15], v6, s[24:27], 0 offen
    v_add_u32 v6, 0x200000, v6
    v_cmp_gt_u32 vcc, 4, v0
    s_and_saveexec_b64 s[36:37], vcc
    buffer_load_dwordx4 v[16:19], v6, s[24:27], 0 offen
    s_mov_b64 exec, s[36:37]
    s_lshl_b32 s30, s29, 10
    v_lshlrev_b32 v7, 2, v1
    v_add_u32 v7, s30, v7
    buffer_load_dword v20, v7, s[12:15], 0 offen offset:0
    buffer_load_dword v21, v7, s[12:15], 0 offen offset:256
    buffer_load_dword v22, v7, s[12:15], 0 offen offset:512
    buffer_load_dword v23, v7, s[12:15], 0 offen offset:768
    v_add_u32 v5, 25165824, v7
    buffer_load_dword v24, v5, s[24:27], 0 offen offset:0
    buffer_load_dword v25, v5, s[24:27], 0 offen offset:256
    buffer_load_dword v26, v5, s[24:27], 0 offen offset:512
    buffer_load_dword v27, v5, s[24:27], 0 offen offset:768
    s_waitcnt vmcnt(8)
    ds_write_b64 v4, v[8:9] offset:0
    ds_write_b64 v4, v[10:11] offset:2064
    ds_write_b64 v4, v[12:13] offset:1024
    ds_write_b64 v4, v[14:15] offset:3088
    v_cmp_gt_u32 vcc, 4, v0
    s_and_saveexec_b64 s[36:37], vcc
    ds_write_b64 v4, v[16:17] offset:2048
    ds_write_b64 v4, v[18:19] offset:4112
    s_mov_b64 exec, s[36:37]
    s_waitcnt lgkmcnt(0)
    s_barrier
    s_mul_i32 s31, s28, 2064
    s_add_u32 s31, s31, 16384
    s_lshl_b32 s32, s28, 11
    v_lshlrev_b32 v2, 3, v1
    v_add_u32 v2, s31, v2
    ds_read_b64 v[28:29], v2 offset:0
    ds_read_b64 v[30:31], v2 offset:512
    ds_read_b64 v[32:33], v2 offset:1024
    ds_read_b64 v[34:35], v2 offset:1536
    v_sub_u32 v3, 256, v1
    v_lshlrev_b32 v3, 3, v3
    v_add_u32 v3, s31, v3
    ds_read_b64 v[36:37], v3
    v_sub_u32 v3, 192, v1
    v_lshlrev_b32 v3, 3, v3
    v_add_u32 v3, s31, v3
    ds_read_b64 v[38:39], v3
    v_sub_u32 v3, 128, v1
    v_lshlrev_b32 v3, 3, v3
    v_add_u32 v3, s31, v3
    ds_read_b64 v[40:41], v3
    v_sub_u32 v3, 64, v1
    v_lshlrev_b32 v3, 3, v3
    v_add_u32 v3, s31, v3
    ds_read_b64 v[42:43], v3
    v_cvt_f32_u32 v44, v1
    s_waitcnt lgkmcnt(0)
    v_cmp_eq_u32 vcc, 0, v1
    s_nop 1
    v_cndmask_b32 v29, v29, 0, vcc
    v_cndmask_b32 v37, v37, 0, vcc
    v_add_f32 v45, 0.0, v44
    v_mul_f32 v45, 0x3b000000, v45
    v_cos_f32 v46, v45
    v_sin_f32 v47, v45
    v_add_f32 v48, v28, v36
    v_sub_f32 v49, v29, v37
    v_sub_f32 v50, v28, v36
    v_add_f32 v51, v29, v37
    v_fma_f32 v52, -v46, v51, v48
    v_fma_f32 v52, -v47, v50, v52
    v_fma_f32 v53, v46, v50, v49
    v_fma_f32 v53, -v47, v51, v53
    v_add_f32 v45, 64.0, v44
    v_mul_f32 v45, 0x3b000000, v45
    v_cos_f32 v46, v45
    v_sin_f32 v47, v45
    v_add_f32 v48, v30, v38
    v_sub_f32 v49, v31, v39
    v_sub_f32 v50, v30, v38
    v_add_f32 v51, v31, v39
    v_fma_f32 v54, -v46, v51, v48
    v_fma_f32 v54, -v47, v50, v54
    v_fma_f32 v55, v46, v50, v49
    v_fma_f32 v55, -v47, v51, v55
    v_add_f32 v45, 128.0, v44
    v_mul_f32 v45, 0x3b000000, v45
    v_cos_f32 v46, v45
    v_sin_f32 v47, v45
    v_add_f32 v48, v32, v40
    v_sub_f32 v49, v33, v41
    v_sub_f32 v50, v32, v40
    v_add_f32 v51, v33, v41
    v_fma_f32 v56, -v46, v51, v48
    v_fma_f32 v56, -v47, v50, v56
    v_fma_f32 v57, v46, v50, v49
    v_fma_f32 v57, -v47, v51, v57
    v_add_f32 v45, 192.0, v44
    v_mul_f32 v45, 0x3b000000, v45
    v_cos_f32 v46, v45
    v_sin_f32 v47, v45
    v_add_f32 v48, v34, v42
    v_sub_f32 v49, v35, v43
    v_sub_f32 v50, v34, v42
    v_add_f32 v51, v35, v43
    v_fma_f32 v58, -v46, v51, v48
    v_fma_f32 v58, -v47, v50, v58
    v_fma_f32 v59, v46, v50, v49
    v_fma_f32 v59, -v47, v51, v59
    v_lshlrev_b32 v28, 3, v1
    v_add_u32 v28, s32, v28
    v_add_f32 v30, v52, v56
    v_add_f32 v31, v53, v57
    v_sub_f32 v32, v52, v56
    v_sub_f32 v33, v53, v57
    v_add_f32 v34, v54, v58
    v_add_f32 v35, v55, v59
    v_sub_f32 v36, v54, v58
    v_sub_f32 v37, v55, v59
    v_add_f32 v38, v30, v34
    v_add_f32 v39, v31, v35
    v_sub_f32 v40, v30, v34
    v_sub_f32 v41, v31, v35
    v_sub_f32 v42, v32, v37
    v_add_f32 v43, v33, v36
    v_add_f32 v46, v32, v37
    v_sub_f32 v47, v33, v36
    v_and_b32 v29, 0, v1
    v_lshrrev_b32 v2, 0, v1
    v_lshl_add_u32 v29, v2, 2, v29
    v_lshlrev_b32 v29, 3, v29
    v_add_u32 v29, s32, v29
    ds_write_b64 v29, v[38:39] offset:0
    ds_write_b64 v29, v[42:43] offset:8
    ds_write_b64 v29, v[40:41] offset:16
    ds_write_b64 v29, v[46:47] offset:24
    s_waitcnt lgkmcnt(0)
    ds_read_b64 v[38:39], v28 offset:0
    ds_read_b64 v[42:43], v28 offset:512
    ds_read_b64 v[40:41], v28 offset:1024
    ds_read_b64 v[46:47], v28 offset:1536
    s_waitcnt lgkmcnt(0)
    v_and_b32 v29, 3, v1
    v_cvt_f32_u32 v29, v29
    v_mul_f32 v30, 0.0625, v29
    v_cos_f32 v31, v30
    v_sin_f32 v32, v30
    s_nop 0
    v_sub_f32 v32, 0, v32
    v_mul_f32 v34, v42, v31
    v_mul_f32 v35, v43, v31
    v_fma_f32 v34, v43, v32, v34
    v_fma_f32 v35, -v42, v32, v35
    v_mul_f32 v30, 0.125, v29
    v_cos_f32 v31, v30
    v_sin_f32 v32, v30
    s_nop 0
    v_sub_f32 v32, 0, v32
    v_mul_f32 v36, v40, v31
    v_mul_f32 v37, v41, v31
    v_fma_f32 v36, v41, v32, v36
    v_fma_f32 v37, -v40, v32, v37
    v_mul_f32 v30, 0.1875, v29
    v_cos_f32 v31, v30
    v_sin_f32 v32, v30
    s_nop 0
    v_sub_f32 v32, 0, v32
    v_mul_f32 v40, v46, v31
    v_mul_f32 v41, v47, v31
    v_fma_f32 v40, v47, v32, v40
    v_fma_f32 v41, -v46, v32, v41
    v_add_f32 v30, v38, v36
    v_add_f32 v31, v39, v37
    v_sub_f32 v32, v38, v36
    v_sub_f32 v33, v39, v37
    v_add_f32 v42, v34, v40
    v_add_f32 v43, v35, v41
    v_sub_f32 v46, v34, v40
    v_sub_f32 v47, v35, v41
    v_add_f32 v34, v30, v42
    v_add_f32 v35, v31, v43
    v_sub_f32 v36, v30, v42
    v_sub_f32 v37, v31, v43
    v_sub_f32 v38, v32, v47
    v_add_f32 v39, v33, v46
    v_add_f32 v40, v32, v47
    v_sub_f32 v41, v33, v46
    v_and_b32 v29, 3, v1
    v_lshrrev_b32 v2, 2, v1
    v_lshl_add_u32 v29, v2, 4, v29
    v_lshlrev_b32 v29, 3, v29
    v_add_u32 v29, s32, v29
    ds_write_b64 v29, v[34:35] offset:0
    ds_write_b64 v29, v[38:39] offset:32
    ds_write_b64 v29, v[36:37] offset:64
    ds_write_b64 v29, v[40:41] offset:96
    s_waitcnt lgkmcnt(0)
    ds_read_b64 v[34:35], v28 offset:0
    ds_read_b64 v[38:39], v28 offset:512
    ds_read_b64 v[36:37], v28 offset:1024
    ds_read_b64 v[40:41], v28 offset:1536
    s_waitcnt lgkmcnt(0)
    v_and_b32 v29, 15, v1
    v_cvt_f32_u32 v29, v29
    v_mul_f32 v30, 0.015625, v29
    v_cos_f32 v31, v30
    v_sin_f32 v32, v30
    s_nop 0
    v_sub_f32 v32, 0, v32
    v_mul_f32 v42, v38, v31
    v_mul_f32 v43, v39, v31
    v_fma_f32 v42, v39, v32, v42
    v_fma_f32 v43, -v38, v32, v43
    v_mul_f32 v30, 0.03125, v29
    v_cos_f32 v31, v30
    v_sin_f32 v32, v30
    s_nop 0
    v_sub_f32 v32, 0, v32
    v_mul_f32 v38, v36, v31
    v_mul_f32 v39, v37, v31
    v_fma_f32 v38, v37, v32, v38
    v_fma_f32 v39, -v36, v32, v39
    v_mul_f32 v30, 0.046875, v29
    v_cos_f32 v31, v30
    v_sin_f32 v32, v30
    s_nop 0
    v_sub_f32 v32, 0, v32
    v_mul_f32 v36, v40, v31
    v_mul_f32 v37, v41, v31
    v_fma_f32 v36, v41, v32, v36
    v_fma_f32 v37, -v40, v32, v37
    v_add_f32 v30, v34, v38
    v_add_f32 v31, v35, v39
    v_sub_f32 v32, v34, v38
    v_sub_f32 v33, v35, v39
    v_add_f32 v40, v42, v36
    v_add_f32 v41, v43, v37
    v_sub_f32 v46, v42, v36
    v_sub_f32 v47, v43, v37
    v_add_f32 v34, v30, v40
    v_add_f32 v35, v31, v41
    v_sub_f32 v36, v30, v40
    v_sub_f32 v37, v31, v41
    v_sub_f32 v38, v32, v47
    v_add_f32 v39, v33, v46
    v_add_f32 v42, v32, v47
    v_sub_f32 v43, v33, v46
    v_and_b32 v29, 15, v1
    v_lshrrev_b32 v2, 4, v1
    v_lshl_add_u32 v29, v2, 6, v29
    v_lshlrev_b32 v29, 3, v29
    v_add_u32 v29, s32, v29
    ds_write_b64 v29, v[34:35] offset:0
    ds_write_b64 v29, v[38:39] offset:128
    ds_write_b64 v29, v[36:37] offset:256
    ds_write_b64 v29, v[42:43] offset:384
    s_waitcnt lgkmcnt(0)
    ds_read_b64 v[34:35], v28 offset:0
    ds_read_b64 v[38:39], v28 offset:512
    ds_read_b64 v[36:37], v28 offset:1024
    ds_read_b64 v[42:43], v28 offset:1536
    s_waitcnt lgkmcnt(0)
    v_and_b32 v29, 63, v1
    v_cvt_f32_u32 v29, v29
    v_mul_f32 v30, 0.00390625, v29
    v_cos_f32 v31, v30
    v_sin_f32 v32, v30
    s_nop 0
    v_sub_f32 v32, 0, v32
    v_mul_f32 v40, v38, v31
    v_mul_f32 v41, v39, v31
    v_fma_f32 v40, v39, v32, v40
    v_fma_f32 v41, -v38, v32, v41
    v_mul_f32 v30, 0.0078125, v29
    v_cos_f32 v31, v30
    v_sin_f32 v32, v30
    s_nop 0
    v_sub_f32 v32, 0, v32
    v_mul_f32 v38, v36, v31
    v_mul_f32 v39, v37, v31
    v_fma_f32 v38, v37, v32, v38
    v_fma_f32 v39, -v36, v32, v39
    v_mul_f32 v30, 0.01171875, v29
    v_cos_f32 v31, v30
    v_sin_f32 v32, v30
    s_nop 0
    v_sub_f32 v32, 0, v32
    v_mul_f32 v36, v42, v31
    v_mul_f32 v37, v43, v31
    v_fma_f32 v36, v43, v32, v36
    v_fma_f32 v37, -v42, v32, v37
    v_add_f32 v30, v34, v38
    v_add_f32 v31, v35, v39
    v_sub_f32 v32, v34, v38
    v_sub_f32 v33, v35, v39
    v_add_f32 v42, v40, v36
    v_add_f32 v43, v41, v37
    v_sub_f32 v46, v40, v36
    v_sub_f32 v47, v41, v37
    v_add_f32 v34, v30, v42
    v_add_f32 v35, v31, v43
    v_sub_f32 v36, v30, v42
    v_sub_f32 v37, v31, v43
    v_sub_f32 v38, v32, v47
    v_add_f32 v39, v33, v46
    v_add_f32 v40, v32, v47
    v_sub_f32 v41, v33, v46
    s_waitcnt vmcnt(0)
    v_cvt_pk_bf16_f32 v34, v34, v34
    v_lshlrev_b32 v34, 16, v34
    v_cvt_pk_bf16_f32 v35, v35, v35
    v_lshlrev_b32 v35, 16, v35
    v_lshlrev_b32 v30, 16, v24
    v_and_b32 v31, 0xffff0000, v24
    v_mul_f32 v34, v34, v30
    v_mul_f32 v35, v35, v31
    v_cvt_pk_bf16_f32 v34, v34, v34
    v_lshlrev_b32 v34, 16, v34
    v_cvt_pk_bf16_f32 v35, v35, v35
    v_lshlrev_b32 v35, 16, v35
    v_lshlrev_b32 v30, 16, v20
    v_and_b32 v31, 0xffff0000, v20
    v_add_f32 v34, v34, v30
    v_add_f32 v35, v35, v31
    v_cvt_pk_bf16_f32 v29, v34, v35
    buffer_store_dword v29, v7, s[16:19], 0 offen offset:0
    v_cvt_pk_bf16_f32 v38, v38, v38
    v_lshlrev_b32 v38, 16, v38
    v_cvt_pk_bf16_f32 v39, v39, v39
    v_lshlrev_b32 v39, 16, v39
    v_lshlrev_b32 v30, 16, v25
    v_and_b32 v31, 0xffff0000, v25
    v_mul_f32 v38, v38, v30
    v_mul_f32 v39, v39, v31
    v_cvt_pk_bf16_f32 v38, v38, v38
    v_lshlrev_b32 v38, 16, v38
    v_cvt_pk_bf16_f32 v39, v39, v39
    v_lshlrev_b32 v39, 16, v39
    v_lshlrev_b32 v30, 16, v21
    v_and_b32 v31, 0xffff0000, v21
    v_add_f32 v38, v38, v30
    v_add_f32 v39, v39, v31
    v_cvt_pk_bf16_f32 v29, v38, v39
    buffer_store_dword v29, v7, s[16:19], 0 offen offset:256
    v_cvt_pk_bf16_f32 v36, v36, v36
    v_lshlrev_b32 v36, 16, v36
    v_cvt_pk_bf16_f32 v37, v37, v37
    v_lshlrev_b32 v37, 16, v37
    v_lshlrev_b32 v30, 16, v26
    v_and_b32 v31, 0xffff0000, v26
    v_mul_f32 v36, v36, v30
    v_mul_f32 v37, v37, v31
    v_cvt_pk_bf16_f32 v36, v36, v36
    v_lshlrev_b32 v36, 16, v36
    v_cvt_pk_bf16_f32 v37, v37, v37
    v_lshlrev_b32 v37, 16, v37
    v_lshlrev_b32 v30, 16, v22
    v_and_b32 v31, 0xffff0000, v22
    v_add_f32 v36, v36, v30
    v_add_f32 v37, v37, v31
    v_cvt_pk_bf16_f32 v29, v36, v37
    buffer_store_dword v29, v7, s[16:19], 0 offen offset:512
    v_cvt_pk_bf16_f32 v40, v40, v40
    v_lshlrev_b32 v40, 16, v40
    v_cvt_pk_bf16_f32 v41, v41, v41
    v_lshlrev_b32 v41, 16, v41
    v_lshlrev_b32 v30, 16, v27
    v_and_b32 v31, 0xffff0000, v27
    v_mul_f32 v40, v40, v30
    v_mul_f32 v41, v41, v31
    v_cvt_pk_bf16_f32 v40, v40, v40
    v_lshlrev_b32 v40, 16, v40
    v_cvt_pk_bf16_f32 v41, v41, v41
    v_lshlrev_b32 v41, 16, v41
    v_lshlrev_b32 v30, 16, v23
    v_and_b32 v31, 0xffff0000, v23
    v_add_f32 v40, v40, v30
    v_add_f32 v41, v41, v31
    v_cvt_pk_bf16_f32 v29, v40, v41
    buffer_store_dword v29, v7, s[16:19], 0 offen offset:768
L_k3_kernel_end:
    s_endpgm
.section .rodata,"a"
.p2align 6
.amdhsa_kernel k1_kernel
  .amdhsa_next_free_vgpr 128
  .amdhsa_next_free_sgpr 102
  .amdhsa_accum_offset 128
  .amdhsa_group_segment_fixed_size 0
  .amdhsa_kernarg_size 72
  .amdhsa_user_sgpr_count 2
  .amdhsa_user_sgpr_kernarg_segment_ptr 1
  .amdhsa_system_sgpr_workgroup_id_x 1
.end_amdhsa_kernel
.p2align 6
.amdhsa_kernel k2_kernel
  .amdhsa_next_free_vgpr 128
  .amdhsa_next_free_sgpr 102
  .amdhsa_accum_offset 128
  .amdhsa_group_segment_fixed_size 0
  .amdhsa_kernarg_size 72
  .amdhsa_user_sgpr_count 2
  .amdhsa_user_sgpr_kernarg_segment_ptr 1
  .amdhsa_system_sgpr_workgroup_id_x 1
.end_amdhsa_kernel
.p2align 6
.amdhsa_kernel k3_kernel
  .amdhsa_next_free_vgpr 128
  .amdhsa_next_free_sgpr 102
  .amdhsa_accum_offset 128
  .amdhsa_group_segment_fixed_size 0
  .amdhsa_kernarg_size 72
  .amdhsa_user_sgpr_count 2
  .amdhsa_user_sgpr_kernarg_segment_ptr 1
  .amdhsa_system_sgpr_workgroup_id_x 1
.end_amdhsa_kernel
```
